```python
import torch

def _softmax(x, axis=-1):
    return torch.softmax(x, dim=axis)
def _gelu(x):
    return torch.nn.functional.gelu(x, approximate="tanh")
def _silu(x):
    return torch.nn.functional.silu(x)
def _sigmoid(x):
    return torch.sigmoid(x)
def _layernorm(x, axis=-1, eps=1e-5):
    m = x.mean(dim=axis, keepdim=True)
    v = x.var(dim=axis, keepdim=True, unbiased=False)
    return (x - m) / torch.sqrt(v + eps)
def _scatter_add(tgt, idx, src, axis=0):
    return tgt.clone().index_add_(axis, idx, src)
def _segment_sum(src, seg, n):
    out = torch.zeros((n,) + src.shape[1:], dtype=src.dtype)
    return out.index_add_(0, seg, src)
def _pad(x, pw):
    flat = tuple(v for pair in reversed(pw) for v in pair)
    return torch.nn.functional.pad(x, flat)

kernel_name = 'standalone__mixer_token_mlp__prompt'

def setup_inputs():

    _w = (lambda a: (lambda t: t.to(torch.bfloat16) if t.is_floating_point() else t)(torch.as_tensor(a)))
    B, S, D, F = 1, 2048, 640, 1536
    return {
        "x": _w((lambda *s: torch.randn(*s, dtype=torch.bfloat16) * 0.05)(B, S, D)),
        "w1": _w((lambda *s: torch.randn(*s, dtype=torch.bfloat16) * 0.2)(S, F) * (S ** -0.5)),
        "b1": _w((lambda *s: torch.randn(*s, dtype=torch.bfloat16) * 1.6)(F) * 0.02),
        "w2": _w((lambda *s: torch.randn(*s, dtype=torch.bfloat16) * 0.05)(F, S) * (F ** -0.5)),
        "b2": _w((lambda *s: torch.randn(*s, dtype=torch.bfloat16) * 0.05)(S) * 0.02),
    }

def reference(x, w1, b1, w2, b2):
    B, S, D = x.shape
    h = _layernorm(x, axis=-1)
    u = torch.einsum("bsd,sf->bdf", h, w1) + b1
    u = _gelu(u)
    y = torch.einsum("bdf,fs->bds", u, w2) + b2
    return (lambda x, *d: x.permute(*d))(y, 0, 2, 1)
```

```asm
; @launch grid=(256,1,1) block=(256,1,1) lds=163840
.amdgcn_target "amdgcn-amd-amdhsa--gfx950"
.text
.globl standalone__mixer_token_mlp__prompt_kernel
.p2align 8
.type standalone__mixer_token_mlp__prompt_kernel,@function
standalone__mixer_token_mlp__prompt_kernel:
    s_cmp_ge_u32 s2, 256
    s_cbranch_scc1 L_end
    s_load_dwordx16 s[4:19], s[0:1], 0
    v_lshrrev_b32 v54, 6, v0
    s_getpc_b64 s[22:23]
L_pc:
    s_lshr_b32 s50, s2, 3
    s_lshl_b32 s51, s50, 9
    v_lshl_add_u32 v55, v54, 7, s51
    v_min_u32 v55, (L_end-L_pc-256-4), v55
    global_load_dword v60, v55, s[22:23] offset:256
    v_and_b32 v1, 63, v0
    v_readfirstlane_b32 s40, v54
    v_lshrrev_b32 v54, 5, v0
    v_and_b32 v55, 31, v0
    v_lshrrev_b32 v56, 7, v0
    v_mul_u32_u24 v56, 12, v56
    v_add_u32 v56, v56, v54
    v_mul_u32_u24 v2, 1280, v56
    v_lshl_add_u32 v2, v55, 3, v2
    s_lshr_b32 s50, s2, 3
    v_mul_u32_u24 v3, 1344, v54
    v_lshl_add_u32 v3, v55, 3, v3
    v_add_u32 v3, 114688, v3
    s_mul_i32 s43, s50, 205
    s_lshr_b32 s43, s43, 11
    s_mul_i32 s51, s43, 10
    s_sub_u32 s42, s50, s51
    s_cmp_ge_u32 s42, 5
    s_cselect_b32 s3, 5, 0
    s_sub_u32 s3, s42, s3
    s_and_b32 s3, s3, 3
    s_mul_i32 s54, s42, 13
    s_lshr_b32 s54, s54, 3
    s_and_b32 s51, s2, 7
    s_sub_u32 s50, 2, s43
    s_cmp_eq_u32 s51, 3
    s_cselect_b32 s43, s50, s43
    s_cmp_ge_u32 s51, 6
    s_cselect_b32 s50, 1, 0
    s_xor_b32 s51, s51, s50
    s_mul_i32 s51, s51, 3
    s_add_u32 s43, s43, s51
    v_lshrrev_b32 v54, 3, v1
    v_and_b32 v55, 6, v54
    v_and_b32 v56, 7, v1
    v_xor_b32 v55, v55, v56
    v_lshlrev_b32 v55, 4, v55
    v_mul_u32_u24 v4, 3072, v54
    v_add_u32 v4, v4, v55
    v_lshl_add_u32 v8, v54, 12, v55
    v_add_u32 v5, 23552, v4
    v_add_u32 v6, 47104, v4
    v_add_u32 v7, 70656, v4
    s_mul_i32 s47, s40, 1572864
    s_lshl_b32 s50, s43, 7
    s_add_u32 s47, s47, s50
    s_add_u32 s48, s47, 1572864
    s_mul_i32 s50, s54, 98304
    s_add_u32 s46, s47, s50
    s_mul_i32 s41, s40, 28672
    s_mov_b32 m0, s41
    s_lshr_b32 s50, s2, 2
    s_lshl_b32 s50, s50, 3
    s_and_b32 s51, s2, 3
    s_add_u32 s50, s50, s51
    s_mul_i32 s50, s50, 5120
    v_lshlrev_b32 v52, 4, v1
    s_waitcnt lgkmcnt(0)
    s_add_u32 s4, s4, s50
    s_addc_u32 s5, s5, 0
    global_load_dwordx2 v[144:145], v2, s[4:5] offset:0 nt
    global_load_dwordx2 v[146:147], v2, s[4:5] offset:256 nt
    global_load_dwordx2 v[148:149], v2, s[4:5] offset:512 nt
    global_load_dwordx2 v[150:151], v2, s[4:5] offset:768 nt
    global_load_dwordx2 v[152:153], v2, s[4:5] offset:1024 nt
    s_mov_b32 s24, s6
    s_mov_b32 s25, s7
    s_mov_b32 s26, 6291456
    s_mov_b32 s27, 0x00020000
    s_cmp_ge_u32 s2, 240
    s_cselect_b32 s26, 0, s26
    s_barrier
    s_cmp_lt_u32 s2, 160
    s_cbranch_scc1 L_rf0
    buffer_load_dwordx4 v4, s[24:27], s46 offen offset:0 lds
    buffer_load_dwordx4 v5, s[24:27], s46 offen offset:1024 lds
    buffer_load_dwordx4 v6, s[24:27], s46 offen offset:2048 lds
    buffer_load_dwordx4 v7, s[24:27], s46 offen offset:3072 lds
    s_add_u32 m0, m0, 4096
    s_add_u32 s46, s46, 98304
    s_cmp_eq_u32 s46, s48
    s_cselect_b32 s46, s47, s46
L_rf0:
L_re0:
    s_add_u32 s4, s18, 0
    s_addc_u32 s5, s19, 0
    s_load_dword s57, s[4:5], 16384
    s_bfe_u32 s44, s2, 0x30003
    s_mov_b32 s55, s44
    s_and_b32 s50, s2, 7
    s_xor_b32 s50, s50, 1
    s_lshl_b32 s50, s50, 2
    s_lshr_b32 s45, s2, 6
    s_add_u32 s45, s45, s50
    v_lshrrev_b32 v57, 4, v1
    s_min_u32 s50, s43, 23
    s_lshl_b32 s50, s50, 1
    s_and_b32 s51, s40, 1
    s_add_u32 s50, s50, s51
    s_lshl_b32 s50, s50, 6
    v_lshl_add_u32 v59, v57, 3, s50
    global_load_dwordx2 v[40:41], v59, s[8:9] offset:0
    global_load_dwordx2 v[42:43], v59, s[8:9] offset:32
    v_and_b32 v58, 15, v1
    s_lshl_b32 s50, s45, 6
    s_lshl_b32 s51, s40, 4
    s_add_u32 s50, s50, s51
    v_add_u32 v33, s50, v58
    v_lshlrev_b32 v56, 1, v33
    global_load_ushort v44, v56, s[12:13]
    s_lshl_b32 s50, s2, 3
    s_add_u32 s50, s50, s40
    s_lshl_b32 s16, s50, 2
    s_load_dword s0, s[4:5], s16
    s_lshr_b32 s50, s40, 1
    s_add_u32 s50, s50, s3
    s_and_b32 s50, s50, 3
    s_lshl_b32 s51, s42, 2
    s_add_u32 s49, s50, s51
    s_mul_i32 s50, s49, 24
    s_add_u32 s50, s50, s43
    s_lshl_b32 s50, s50, 4
    s_and_b32 s51, s40, 1
    s_add_u32 s50, s50, s51
    s_lshl_b32 s50, s50, 2
    s_add_u32 s17, s50, 32768
    s_load_dword s1, s[4:5], s17
    s_lshr_b32 s50, s40, 1
    s_add_u32 s50, s50, s3
    s_add_u32 s50, s50, 2
    s_and_b32 s50, s50, 3
    s_lshl_b32 s51, s42, 2
    s_add_u32 s52, s50, s51
    s_mul_i32 s50, s52, 24
    s_add_u32 s50, s50, s43
    s_lshl_b32 s50, s50, 4
    s_and_b32 s51, s40, 1
    s_add_u32 s50, s50, s51
    s_lshl_b32 s50, s50, 2
    s_add_u32 s58, s50, 32768
    s_load_dword s59, s[4:5], s58
    s_mov_b32 s32, s18
    s_mov_b32 s33, s19
    s_mov_b32 s34, 9306112
    s_mov_b32 s35, 0x00020000
    v_lshrrev_b32 v57, 4, v1
    v_and_b32 v58, 15, v1
    v_and_b32 v45, 0x70, v52
    v_lshl_add_u32 v45, v57, 17, v45
    v_lshrrev_b32 v58, 3, v58
    v_lshl_add_u32 v45, v58, 8, v45
    v_bfe_u32 v54, v1, 2, 2
    v_mul_u32_u24 v54, 1344, v54
    v_add_u32 v54, 114688, v54
    v_and_b32 v55, 3, v1
    s_lshl_b32 s50, s40, 2
    v_add_u32 v57, s50, v57
    v_mul_u32_u24 v56, 205, v57
    v_lshrrev_b32 v56, 10, v56
    v_mul_u32_u24 v58, 5, v56
    v_sub_u32 v58, v57, v58
    v_lshrrev_b32 v59, 2, v58
    v_mul_u32_u24 v46, 896, v59
    v_lshlrev_b32 v59, 1, v59
    v_sub_u32 v59, 7, v59
    v_lshlrev_b32 v56, v59, v56
    v_add3_u32 v56, v56, v54, v46
    v_lshrrev_b32 v59, 1, v58
    v_lshl_add_u32 v56, v59, 6, v56
    v_and_b32 v59, 1, v58
    v_lshl_add_u32 v56, v59, 3, v56
    v_lshrrev_b32 v58, 2, v58
    v_sub_u32 v58, 4, v58
    v_lshlrev_b32 v58, v58, v55
    v_add_u32 v46, v56, v58
    v_add_u32 v57, 16, v57
    v_mul_u32_u24 v56, 205, v57
    v_lshrrev_b32 v56, 10, v56
    v_mul_u32_u24 v58, 5, v56
    v_sub_u32 v58, v57, v58
    v_lshrrev_b32 v59, 2, v58
    v_mul_u32_u24 v47, 896, v59
    v_lshlrev_b32 v59, 1, v59
    v_sub_u32 v59, 7, v59
    v_lshlrev_b32 v56, v59, v56
    v_add3_u32 v56, v56, v54, v47
    v_lshrrev_b32 v59, 1, v58
    v_lshl_add_u32 v56, v59, 6, v56
    v_and_b32 v59, 1, v58
    v_lshl_add_u32 v56, v59, 3, v56
    v_lshrrev_b32 v58, 2, v58
    v_sub_u32 v58, 4, v58
    v_lshlrev_b32 v58, v58, v55
    v_add_u32 v47, v56, v58
    v_add_u32 v57, 16, v57
    v_mul_u32_u24 v56, 205, v57
    v_lshrrev_b32 v56, 10, v56
    v_mul_u32_u24 v58, 5, v56
    v_sub_u32 v58, v57, v58
    v_lshrrev_b32 v59, 2, v58
    v_mul_u32_u24 v48, 896, v59
    v_lshlrev_b32 v59, 1, v59
    v_sub_u32 v59, 7, v59
    v_lshlrev_b32 v56, v59, v56
    v_add3_u32 v56, v56, v54, v48
    v_lshrrev_b32 v59, 1, v58
    v_lshl_add_u32 v56, v59, 6, v56
    v_and_b32 v59, 1, v58
    v_lshl_add_u32 v56, v59, 3, v56
    v_lshrrev_b32 v58, 2, v58
    v_sub_u32 v58, 4, v58
    v_lshlrev_b32 v58, v58, v55
    v_add_u32 v48, v56, v58
    s_lshl_b32 s56, s2, 9
    s_lshl_b32 s50, s40, 19
    s_add_u32 s56, s56, s50
    s_add_u32 s56, s56, 131072
    s_cmp_lt_u32 s2, 160
    s_cbranch_scc1 L_rf1
    buffer_load_dwordx4 v4, s[24:27], s46 offen offset:0 lds
    buffer_load_dwordx4 v5, s[24:27], s46 offen offset:1024 lds
    buffer_load_dwordx4 v6, s[24:27], s46 offen offset:2048 lds
    buffer_load_dwordx4 v7, s[24:27], s46 offen offset:3072 lds
    s_add_u32 m0, m0, 4096
    s_add_u32 s46, s46, 98304
    s_cmp_eq_u32 s46, s48
    s_cselect_b32 s46, s47, s46
L_rf1:
L_re1:
    s_cmp_lt_u32 s2, 160
    s_cbranch_scc1 L_rf2
    s_waitcnt vmcnt(11)
    s_branch L_re2
L_rf2:
    s_waitcnt vmcnt(3)
    buffer_load_dwordx4 v4, s[24:27], s46 offen offset:0 lds
    buffer_load_dwordx4 v5, s[24:27], s46 offen offset:1024 lds
    buffer_load_dwordx4 v6, s[24:27], s46 offen offset:2048 lds
    buffer_load_dwordx4 v7, s[24:27], s46 offen offset:3072 lds
    s_add_u32 m0, m0, 4096
    s_add_u32 s46, s46, 98304
    s_cmp_eq_u32 s46, s48
    s_cselect_b32 s46, s47, s46
    buffer_load_dwordx4 v4, s[24:27], s46 offen offset:0 lds
    buffer_load_dwordx4 v5, s[24:27], s46 offen offset:1024 lds
L_re2:
    v_lshlrev_b32 v156, 16, v144
    v_and_b32 v157, 0xffff0000, v144
    v_lshlrev_b32 v158, 16, v145
    v_and_b32 v159, 0xffff0000, v145
    v_pk_add_f32 v[54:55], v[156:157], v[158:159]
    v_lshlrev_b32 v160, 16, v146
    v_and_b32 v161, 0xffff0000, v146
    v_lshlrev_b32 v162, 16, v147
    v_and_b32 v163, 0xffff0000, v147
    v_pk_add_f32 v[54:55], v[54:55], v[160:161]
    v_pk_add_f32 v[54:55], v[54:55], v[162:163]
    v_lshlrev_b32 v164, 16, v148
    v_and_b32 v165, 0xffff0000, v148
    v_lshlrev_b32 v166, 16, v149
    v_and_b32 v167, 0xffff0000, v149
    v_pk_add_f32 v[54:55], v[54:55], v[164:165]
    v_pk_add_f32 v[54:55], v[54:55], v[166:167]
    v_lshlrev_b32 v168, 16, v150
    v_and_b32 v169, 0xffff0000, v150
    v_lshlrev_b32 v170, 16, v151
    v_and_b32 v171, 0xffff0000, v151
    v_pk_add_f32 v[54:55], v[54:55], v[168:169]
    v_pk_add_f32 v[54:55], v[54:55], v[170:171]
    v_lshlrev_b32 v172, 16, v152
    v_and_b32 v173, 0xffff0000, v152
    v_lshlrev_b32 v174, 16, v153
    v_and_b32 v175, 0xffff0000, v153
    v_pk_add_f32 v[54:55], v[54:55], v[172:173]
    v_pk_add_f32 v[54:55], v[54:55], v[174:175]
    v_add_f32 v54, v54, v55
    s_nop 1
    v_add_f32_dpp v54, v54, v54 row_ror:8 row_mask:0xf bank_mask:0xf
    s_nop 1
    v_add_f32_dpp v54, v54, v54 row_ror:4 row_mask:0xf bank_mask:0xf
    s_nop 1
    v_add_f32_dpp v54, v54, v54 row_ror:2 row_mask:0xf bank_mask:0xf
    s_nop 1
    v_add_f32_dpp v54, v54, v54 row_ror:1 row_mask:0xf bank_mask:0xf
    v_mov_b32 v55, v54
    s_nop 1
    v_permlane16_swap_b32 v55, v54
    v_add_f32 v54, v54, v55
    v_mul_f32 v54, 0xbacccccd, v54
    v_mov_b32 v55, v54
    v_pk_add_f32 v[156:157], v[156:157], v[54:55]
    v_pk_add_f32 v[158:159], v[158:159], v[54:55]
    v_pk_add_f32 v[160:161], v[160:161], v[54:55]
    v_pk_add_f32 v[162:163], v[162:163], v[54:55]
    v_pk_add_f32 v[164:165], v[164:165], v[54:55]
    v_pk_add_f32 v[166:167], v[166:167], v[54:55]
    v_pk_add_f32 v[168:169], v[168:169], v[54:55]
    v_pk_add_f32 v[170:171], v[170:171], v[54:55]
    v_pk_add_f32 v[172:173], v[172:173], v[54:55]
    v_pk_add_f32 v[174:175], v[174:175], v[54:55]
    v_pk_mul_f32 v[54:55], v[156:157], v[156:157]
    v_pk_fma_f32 v[54:55], v[158:159], v[158:159], v[54:55]
    v_pk_fma_f32 v[54:55], v[160:161], v[160:161], v[54:55]
    v_pk_fma_f32 v[54:55], v[162:163], v[162:163], v[54:55]
    v_pk_fma_f32 v[54:55], v[164:165], v[164:165], v[54:55]
    v_pk_fma_f32 v[54:55], v[166:167], v[166:167], v[54:55]
    v_pk_fma_f32 v[54:55], v[168:169], v[168:169], v[54:55]
    v_pk_fma_f32 v[54:55], v[170:171], v[170:171], v[54:55]
    v_pk_fma_f32 v[54:55], v[172:173], v[172:173], v[54:55]
    v_pk_fma_f32 v[54:55], v[174:175], v[174:175], v[54:55]
    v_add_f32 v54, v54, v55
    s_nop 1
    v_add_f32_dpp v54, v54, v54 row_ror:8 row_mask:0xf bank_mask:0xf
    s_nop 1
    v_add_f32_dpp v54, v54, v54 row_ror:4 row_mask:0xf bank_mask:0xf
    s_nop 1
    v_add_f32_dpp v54, v54, v54 row_ror:2 row_mask:0xf bank_mask:0xf
    s_nop 1
    v_add_f32_dpp v54, v54, v54 row_ror:1 row_mask:0xf bank_mask:0xf
    v_mov_b32 v55, v54
    s_nop 1
    v_permlane16_swap_b32 v55, v54
    v_add_f32 v54, v54, v55
    v_mov_b32 v55, 0x3727c5ac
    v_fmac_f32 v55, 0x3acccccd, v54
    v_rsq_f32 v54, v55
    s_nop 0
    v_mov_b32 v55, v54
    v_pk_mul_f32 v[156:157], v[156:157], v[54:55]
    v_pk_mul_f32 v[158:159], v[158:159], v[54:55]
    v_pk_mul_f32 v[160:161], v[160:161], v[54:55]
    v_pk_mul_f32 v[162:163], v[162:163], v[54:55]
    v_pk_mul_f32 v[164:165], v[164:165], v[54:55]
    v_pk_mul_f32 v[166:167], v[166:167], v[54:55]
    v_pk_mul_f32 v[168:169], v[168:169], v[54:55]
    v_pk_mul_f32 v[170:171], v[170:171], v[54:55]
    v_pk_mul_f32 v[172:173], v[172:173], v[54:55]
    v_pk_mul_f32 v[174:175], v[174:175], v[54:55]
    v_cvt_pk_bf16_f32 v144, v156, v157
    v_cvt_pk_bf16_f32 v145, v158, v159
    ds_write_b64 v3, v[144:145] offset:0
    v_cvt_pk_bf16_f32 v146, v160, v161
    v_cvt_pk_bf16_f32 v147, v162, v163
    ds_write_b64 v3, v[146:147] offset:256
    v_cvt_pk_bf16_f32 v148, v164, v165
    v_cvt_pk_bf16_f32 v149, v166, v167
    ds_write_b64 v3, v[148:149] offset:512
    v_cvt_pk_bf16_f32 v150, v168, v169
    v_cvt_pk_bf16_f32 v151, v170, v171
    ds_write_b64 v3, v[150:151] offset:768
    v_cvt_pk_bf16_f32 v152, v172, v173
    v_cvt_pk_bf16_f32 v153, v174, v175
    ds_write_b64 v3, v[152:153] offset:1024
    s_cmp_lt_u32 s2, 160
    s_cbranch_scc1 L_rf3
    s_branch L_re3
L_rf3:
    buffer_load_dwordx4 v6, s[24:27], s46 offen offset:2048 lds
    buffer_load_dwordx4 v7, s[24:27], s46 offen offset:3072 lds
    s_add_u32 m0, m0, 4096
    s_add_u32 s46, s46, 98304
    s_cmp_eq_u32 s46, s48
    s_cselect_b32 s46, s47, s46
L_re3:
    s_waitcnt lgkmcnt(0)
    s_barrier
    ds_read_b64_tr_b16 v[156:157], v46
    ds_read_b64_tr_b16 v[158:159], v46 offset:5376
    ds_read_b64_tr_b16 v[160:161], v47
    ds_read_b64_tr_b16 v[162:163], v47 offset:5376
    ds_read_b64_tr_b16 v[164:165], v48
    ds_read_b64_tr_b16 v[166:167], v48 offset:5376
    s_add_u32 s50, s56, 2097152
    s_add_u32 s51, s56, 4194304
    s_cmp_ge_u32 s40, 2
    s_cselect_b32 s51, 0x40000000, s51
    s_waitcnt lgkmcnt(4)
    buffer_store_dwordx4 v[156:159], v45, s[32:35], s56 offen sc1
    s_waitcnt lgkmcnt(2)
    buffer_store_dwordx4 v[160:163], v45, s[32:35], s50 offen sc1
    s_waitcnt lgkmcnt(0)
    buffer_store_dwordx4 v[164:167], v45, s[32:35], s51 offen sc1
    s_cmp_ge_u32 s2, 240
    s_cbranch_scc1 L_idle
    s_waitcnt vmcnt(9)
    buffer_load_dwordx4 v4, s[24:27], s46 offen offset:0 lds
    s_mul_i32 s20, s57, 1664524
    s_add_u32 s20, s20, 1013904223
    s_add_u32 s57, s57, s20
    v_mov_b32 v39, s57
    s_sub_u32 s0, s57, s0
    s_sub_u32 s1, s57, s1
    s_sub_u32 s59, s57, s59
    v_lshrrev_b32 v54, 2, v1
    s_waitcnt vmcnt(9)
    buffer_load_dwordx4 v5, s[24:27], s46 offen offset:1024 lds
    v_lshlrev_b32 v21, 7, v54
    v_bfe_u32 v54, v1, 3, 2
    v_lshl_add_u32 v21, v54, 5, v21
    v_and_b32 v54, 3, v1
    v_lshl_add_u32 v21, v54, 3, v21
    v_add_u32 v21, s41, v21
    s_lshl_b32 s50, s40, 5
    v_xor_b32 v25, s50, v21
    s_waitcnt vmcnt(9)
    buffer_load_dwordx4 v6, s[24:27], s46 offen offset:2048 lds
    s_and_b32 s50, s40, 1
    s_lshl_b32 s50, s50, 6
    v_xor_b32 v21, s50, v21
    v_xor_b32 v22, 32, v21
    v_xor_b32 v23, 64, v21
    v_xor_b32 v24, 96, v21
    v_lshrrev_b32 v57, 4, v1
    s_waitcnt vmcnt(9)
    buffer_load_dwordx4 v7, s[24:27], s46 offen offset:3072 lds
    s_add_u32 m0, m0, 4096
    s_add_u32 s46, s46, 98304
    s_cmp_eq_u32 s46, s48
    s_cselect_b32 s46, s47, s46
    ds_read_b64_tr_b16 a[0:1], v21 offset:0
    ds_read_b64_tr_b16 a[2:3], v21 offset:2048
    v_mul_u32_u24 v33, 1280, v33
    v_lshl_add_u32 v34, v57, 3, v33
    v_lshl_add_u32 v33, v57, 4, v33
    v_xor_b32 v26, 32, v25
    v_xor_b32 v27, 64, v25
    v_xor_b32 v28, 96, v25
    v_add_u32 v9, 31744, v8
    v_add_u32 v10, 63488, v8
    s_waitcnt vmcnt(9)
    buffer_load_dwordx4 v4, s[24:27], s46 offen offset:0 lds
    ds_read_b64_tr_b16 a[4:5], v22 offset:0
    ds_read_b64_tr_b16 a[6:7], v22 offset:2048
    v_add_u32 v11, 95232, v8
    v_and_b32 v16, 0x70, v52
    v_lshrrev_b32 v54, 3, v1
    v_lshl_add_u32 v53, v54, 8, v16
    v_lshl_add_u32 v16, v54, 8, v16
    v_add_u32 v17, 98304, v16
    v_add_u32 v18, 196608, v16
    v_add_u32 v19, 294912, v16
    s_waitcnt vmcnt(9)
    buffer_load_dwordx4 v5, s[24:27], s46 offen offset:1024 lds
    ds_read_b64_tr_b16 a[8:9], v23 offset:0
    ds_read_b64_tr_b16 a[10:11], v23 offset:2048
    v_add_u32 v20, 393216, v16
    v_min_u32 v54, 23, v1
    v_mul_u32_u24 v55, 43, v54
    v_lshrrev_b32 v55, 9, v55
    v_mul_u32_u24 v55, 18, v55
    v_lshrrev_b32 v56, 1, v54
    s_mul_i32 s50, s44, 120
    s_mul_i32 s51, s40, 6
    s_add_u32 s50, s50, s51
    v_add3_u32 v55, v55, v56, s50
    v_and_b32 v54, 1, v54
    v_lshlrev_b32 v54, 2, v54
    v_lshl_add_u32 v36, v55, 6, v54
    v_add_u32 v36, 32768, v36
    v_min_u32 v54, 35, v1
    v_mul_u32_u24 v55, 43, v54
    v_lshrrev_b32 v55, 9, v55
    v_mul_u32_u24 v55, 18, v55
    v_lshrrev_b32 v56, 1, v54
    s_mul_i32 s50, s44, 120
    s_mul_i32 s51, s40, 6
    s_add_u32 s50, s50, s51
    v_add3_u32 v55, v55, v56, s50
    v_and_b32 v54, 1, v54
    v_lshlrev_b32 v54, 2, v54
    v_lshl_add_u32 v37, v55, 6, v54
    v_add_u32 v37, 35840, v37
    s_mov_b32 s28, s10
    s_mov_b32 s29, s11
    s_mov_b32 s30, 6291456
    s_mov_b32 s31, 0x00020000
    s_mov_b32 s36, s14
    s_mov_b32 s37, s15
    s_mov_b32 s38, 2621440
    s_mov_b32 s39, 0x00020000
    s_waitcnt vmcnt(6)
    s_atomic_add s0, s[4:5], s16
    v_lshlrev_b32 v35, 5, v0
    buffer_load_dwordx4 v6, s[24:27], s46 offen offset:2048 lds
    ds_read_b64_tr_b16 a[12:13], v24 offset:0
    ds_read_b64_tr_b16 a[14:15], v24 offset:2048
    ds_read_b64_tr_b16 a[16:17], v21 offset:4096
    ds_read_b64_tr_b16 a[18:19], v21 offset:6144
    s_lshr_b32 s50, s40, 1
    s_xor_b32 s50, s50, 1
    s_add_u32 s50, s50, s3
    s_and_b32 s50, s50, 3
    s_lshl_b32 s51, s50, 17
    v_add_u32 v12, s51, v53
    s_lshr_b32 s50, s40, 1
    s_add_u32 s50, s50, s3
    s_and_b32 s50, s50, 3
    s_lshl_b32 s51, s50, 17
    v_add_u32 v13, s51, v53
    s_waitcnt vmcnt(6)
    buffer_load_dwordx4 v7, s[24:27], s46 offen offset:3072 lds
    s_add_u32 m0, m0, 4096
    s_add_u32 s46, s46, 98304
    s_cmp_eq_u32 s46, s48
    s_cselect_b32 s46, s47, s46
    ds_read_b64_tr_b16 a[20:21], v22 offset:4096
    ds_read_b64_tr_b16 a[22:23], v22 offset:6144
    s_lshr_b32 s50, s40, 1
    s_xor_b32 s50, s50, 1
    s_add_u32 s50, s50, s3
    s_add_u32 s50, s50, 2
    s_and_b32 s50, s50, 3
    s_lshl_b32 s51, s50, 17
    v_add_u32 v14, s51, v53
    s_lshr_b32 s50, s40, 1
    s_add_u32 s50, s50, s3
    s_add_u32 s50, s50, 2
    s_and_b32 s50, s50, 3
    s_lshl_b32 s51, s50, 17
    v_add_u32 v15, s51, v53
    s_waitcnt vmcnt(6)
    buffer_load_dwordx4 v4, s[24:27], s46 offen offset:0 lds
    ds_read_b64_tr_b16 a[24:25], v23 offset:4096
    s_waitcnt lgkmcnt(7)
    ds_read_b64_tr_b16 a[26:27], v23 offset:6144
    s_mul_i32 s49, s49, 48
    s_lshl_b32 s50, s43, 1
    s_add_u32 s49, s49, s50
    s_and_b32 s51, s40, 1
    s_add_u32 s49, s49, s51
    s_lshl_b32 s49, s49, 11
    s_add_u32 s49, s49, 5373952
    s_mul_i32 s52, s52, 48
    s_lshl_b32 s50, s43, 1
    s_add_u32 s52, s52, s50
    s_and_b32 s51, s40, 1
    s_add_u32 s52, s52, s51
    s_lshl_b32 s52, s52, 11
    s_add_u32 s52, s52, 5373952
    s_waitcnt vmcnt(6)
    buffer_load_dwordx4 v5, s[24:27], s46 offen offset:1024 lds
    ds_read_b64_tr_b16 a[28:29], v24 offset:4096
    ds_read_b64_tr_b16 a[30:31], v24 offset:6144
    s_lshl_b32 s56, s42, 19
    s_lshl_b32 s51, s40, 15
    s_add_u32 s56, s56, s51
    s_add_u32 s56, s56, 131072
    s_add_u32 s51, s54, 0
    s_and_b32 s51, s51, 15
    s_lshl_b32 s51, s51, 11
    s_add_u32 s60, s51, s56
    s_waitcnt vmcnt(6)
    buffer_load_dwordx4 v6, s[24:27], s46 offen offset:2048 lds
    ds_read_b64_tr_b16 a[32:33], v21 offset:8192
    ds_read_b64_tr_b16 a[34:35], v21 offset:10240
    s_add_u32 s51, s54, 1
    s_and_b32 s51, s51, 15
    s_lshl_b32 s51, s51, 11
    s_add_u32 s61, s51, s56
    s_add_u32 s51, s54, 2
    s_and_b32 s51, s51, 15
    s_lshl_b32 s51, s51, 11
    s_add_u32 s62, s51, s56
    s_waitcnt vmcnt(6)
    buffer_load_dwordx4 v7, s[24:27], s46 offen offset:3072 lds
    s_add_u32 m0, m0, 4096
    s_add_u32 s46, s46, 98304
    s_cmp_eq_u32 s46, s48
    s_cselect_b32 s46, s47, s46
    ds_read_b64_tr_b16 a[36:37], v22 offset:8192
    s_waitcnt lgkmcnt(7)
    ds_read_b64_tr_b16 a[38:39], v22 offset:10240
    s_add_u32 s51, s54, 3
    s_and_b32 s51, s51, 15
    s_lshl_b32 s51, s51, 11
    s_add_u32 s63, s51, s56
    s_add_u32 s51, s54, 4
    s_and_b32 s51, s51, 15
    s_lshl_b32 s51, s51, 11
    s_add_u32 s64, s51, s56
    s_waitcnt vmcnt(6)
    buffer_load_dwordx4 v4, s[24:27], s46 offen offset:0 lds
    ds_read_b64_tr_b16 a[40:41], v23 offset:8192
    ds_read_b64_tr_b16 a[42:43], v23 offset:10240
    s_add_u32 s51, s54, 5
    s_and_b32 s51, s51, 15
    s_lshl_b32 s51, s51, 11
    s_add_u32 s65, s51, s56
    s_add_u32 s51, s54, 6
    s_and_b32 s51, s51, 15
    s_lshl_b32 s51, s51, 11
    s_add_u32 s66, s51, s56
    s_waitcnt vmcnt(6)
    buffer_load_dwordx4 v5, s[24:27], s46 offen offset:1024 lds
    ds_read_b64_tr_b16 a[44:45], v24 offset:8192
    ds_read_b64_tr_b16 a[46:47], v24 offset:10240
    s_add_u32 s51, s54, 7
    s_and_b32 s51, s51, 15
    s_lshl_b32 s51, s51, 11
    s_add_u32 s67, s51, s56
    s_add_u32 s51, s54, 8
    s_and_b32 s51, s51, 15
    s_lshl_b32 s51, s51, 11
    s_add_u32 s68, s51, s56
    s_waitcnt vmcnt(6)
    buffer_load_dwordx4 v6, s[24:27], s46 offen offset:2048 lds
    ds_read_b64_tr_b16 a[48:49], v21 offset:12288
    s_waitcnt lgkmcnt(7)
    ds_read_b64_tr_b16 a[50:51], v21 offset:14336
    s_add_u32 s51, s54, 9
    s_and_b32 s51, s51, 15
    s_lshl_b32 s51, s51, 11
    s_add_u32 s69, s51, s56
    s_add_u32 s51, s54, 10
    s_and_b32 s51, s51, 15
    s_lshl_b32 s51, s51, 11
    s_add_u32 s70, s51, s56
    s_waitcnt vmcnt(6)
    buffer_load_dwordx4 v7, s[24:27], s46 offen offset:3072 lds
    s_add_u32 m0, m0, 4096
    s_add_u32 s46, s46, 98304
    s_cmp_eq_u32 s46, s48
    s_cselect_b32 s46, s47, s46
    ds_read_b64_tr_b16 a[52:53], v22 offset:12288
    ds_read_b64_tr_b16 a[54:55], v22 offset:14336
    s_add_u32 s51, s54, 11
    s_and_b32 s51, s51, 15
    s_lshl_b32 s51, s51, 11
    s_add_u32 s71, s51, s56
    s_add_u32 s51, s54, 12
    s_and_b32 s51, s51, 15
    s_lshl_b32 s51, s51, 11
    s_add_u32 s72, s51, s56
    s_waitcnt vmcnt(6)
    buffer_load_dwordx4 v4, s[24:27], s46 offen offset:0 lds
    ds_read_b64_tr_b16 a[56:57], v23 offset:12288
    ds_read_b64_tr_b16 a[58:59], v23 offset:14336
    s_add_u32 s51, s54, 13
    s_and_b32 s51, s51, 15
    s_lshl_b32 s51, s51, 11
    s_add_u32 s73, s51, s56
    s_add_u32 s51, s54, 14
    s_and_b32 s51, s51, 15
    s_lshl_b32 s51, s51, 11
    s_add_u32 s74, s51, s56
    s_waitcnt vmcnt(6)
    buffer_load_dwordx4 v5, s[24:27], s46 offen offset:1024 lds
    ds_read_b64_tr_b16 a[60:61], v24 offset:12288
    s_waitcnt lgkmcnt(7)
    ds_read_b64_tr_b16 a[62:63], v24 offset:14336
    s_add_u32 s51, s54, 15
    s_and_b32 s51, s51, 15
    s_lshl_b32 s51, s51, 11
    s_add_u32 s75, s51, s56
    s_xor_b32 s50, s40, 0
    s_mul_i32 s50, s50, 12288
    s_add_u32 s50, s50, 114688
    v_add_u32 v29, s50, v52
    s_waitcnt vmcnt(6)
    buffer_load_dwordx4 v6, s[24:27], s46 offen offset:2048 lds
    ds_read_b64_tr_b16 a[64:65], v21 offset:16384
    ds_read_b64_tr_b16 a[66:67], v21 offset:18432
    s_xor_b32 s50, s40, 1
    s_mul_i32 s50, s50, 12288
    s_add_u32 s50, s50, 114688
    v_add_u32 v30, s50, v52
    s_xor_b32 s50, s40, 2
    s_mul_i32 s50, s50, 12288
    s_add_u32 s50, s50, 114688
    v_add_u32 v31, s50, v52
    s_waitcnt vmcnt(6)
    buffer_load_dwordx4 v7, s[24:27], s46 offen offset:3072 lds
    s_mov_b32 m0, s41
    s_add_u32 s46, s46, 98304
    s_cmp_eq_u32 s46, s48
    s_cselect_b32 s46, s47, s46
    ds_read_b64_tr_b16 a[68:69], v22 offset:16384
    ds_read_b64_tr_b16 a[70:71], v22 offset:18432
    s_xor_b32 s50, s40, 3
    s_mul_i32 s50, s50, 12288
    s_add_u32 s50, s50, 114688
    v_add_u32 v32, s50, v52
    v_mov_b32 v50, 0xc0135761
    v_mov_b32 v51, 0xbdd2d3e8
    v_lshlrev_b32 v80, 16, v40
    s_waitcnt vmcnt(6)
    buffer_load_dwordx4 v4, s[24:27], s46 offen offset:0 lds
    ds_read_b64_tr_b16 a[72:73], v23 offset:16384
    s_waitcnt lgkmcnt(7)
    ds_read_b64_tr_b16 a[74:75], v23 offset:18432
    v_and_b32 v81, 0xffff0000, v40
    v_lshlrev_b32 v82, 16, v41
    v_and_b32 v83, 0xffff0000, v41
    v_lshlrev_b32 v84, 16, v42
    v_and_b32 v85, 0xffff0000, v42
    v_lshlrev_b32 v86, 16, v43
    v_and_b32 v87, 0xffff0000, v43
    v_lshlrev_b32 v112, 16, v40
    s_waitcnt vmcnt(6)
    buffer_load_dwordx4 v5, s[24:27], s46 offen offset:1024 lds
    ds_read_b64_tr_b16 a[76:77], v24 offset:16384
    ds_read_b64_tr_b16 a[78:79], v24 offset:18432
    v_and_b32 v113, 0xffff0000, v40
    v_lshlrev_b32 v114, 16, v41
    v_and_b32 v115, 0xffff0000, v41
    v_lshlrev_b32 v116, 16, v42
    v_and_b32 v117, 0xffff0000, v42
    v_lshlrev_b32 v118, 16, v43
    v_and_b32 v119, 0xffff0000, v43
    s_waitcnt vmcnt(6)
    buffer_load_dwordx4 v6, s[24:27], s46 offen offset:2048 lds
    ds_read_b64_tr_b16 a[80:81], v21 offset:20480
    ds_read_b64_tr_b16 a[82:83], v21 offset:22528
    s_waitcnt vmcnt(6)
    buffer_load_dwordx4 v7, s[24:27], s46 offen offset:3072 lds
    s_add_u32 m0, m0, 4096
    s_add_u32 s46, s46, 98304
    s_cmp_eq_u32 s46, s48
    s_cselect_b32 s46, s47, s46
    ds_read_b64_tr_b16 a[84:85], v22 offset:20480
    s_waitcnt lgkmcnt(7)
    ds_read_b64_tr_b16 a[86:87], v22 offset:22528
    s_waitcnt vmcnt(6)
    buffer_load_dwordx4 v4, s[24:27], s46 offen offset:0 lds
    ds_read_b64_tr_b16 a[88:89], v23 offset:20480
    ds_read_b64_tr_b16 a[90:91], v23 offset:22528
    s_waitcnt vmcnt(6)
    buffer_load_dwordx4 v5, s[24:27], s46 offen offset:1024 lds
    ds_read_b64_tr_b16 a[92:93], v24 offset:20480
    ds_read_b64_tr_b16 a[94:95], v24 offset:22528
    s_waitcnt vmcnt(6)
    buffer_load_dwordx4 v6, s[24:27], s46 offen offset:2048 lds
    ds_read_b64_tr_b16 a[96:97], v21 offset:24576
    s_waitcnt lgkmcnt(7)
    ds_read_b64_tr_b16 a[98:99], v21 offset:26624
    s_waitcnt vmcnt(6)
    buffer_load_dwordx4 v7, s[24:27], s46 offen offset:3072 lds
    s_add_u32 m0, m0, 4096
    s_add_u32 s46, s46, 98304
    s_cmp_eq_u32 s46, s48
    s_cselect_b32 s46, s47, s46
    ds_read_b64_tr_b16 a[100:101], v22 offset:24576
    ds_read_b64_tr_b16 a[102:103], v22 offset:26624
    s_waitcnt vmcnt(6)
    buffer_load_dwordx4 v4, s[24:27], s46 offen offset:0 lds
    ds_read_b64_tr_b16 a[104:105], v23 offset:24576
    ds_read_b64_tr_b16 a[106:107], v23 offset:26624
    s_waitcnt vmcnt(6)
    buffer_load_dwordx4 v5, s[24:27], s46 offen offset:1024 lds
    ds_read_b64_tr_b16 a[108:109], v24 offset:24576
    s_waitcnt lgkmcnt(7)
    ds_read_b64_tr_b16 a[110:111], v24 offset:26624
    s_waitcnt vmcnt(6)
    buffer_load_dwordx4 v6, s[24:27], s46 offen offset:2048 lds
    ds_read_b64_tr_b16 a[112:113], v21 offset:0
    ds_read_b64_tr_b16 a[114:115], v21 offset:2048
    s_waitcnt vmcnt(6)
    buffer_load_dwordx4 v7, s[24:27], s46 offen offset:3072 lds
    s_add_u32 m0, m0, 4096
    s_add_u32 s46, s46, 98304
    s_cmp_eq_u32 s46, s48
    s_cselect_b32 s46, s47, s46
    ds_read_b64_tr_b16 a[116:117], v22 offset:0
    ds_read_b64_tr_b16 a[118:119], v22 offset:2048
    s_waitcnt vmcnt(6)
    buffer_load_dwordx4 v4, s[24:27], s46 offen offset:0 lds
    ds_read_b64_tr_b16 a[120:121], v23 offset:0
    s_waitcnt lgkmcnt(7)
    ds_read_b64_tr_b16 a[122:123], v23 offset:2048
    s_waitcnt vmcnt(6)
    buffer_load_dwordx4 v5, s[24:27], s46 offen offset:1024 lds
    ds_read_b64_tr_b16 a[124:125], v24 offset:0
    ds_read_b64_tr_b16 a[126:127], v24 offset:2048
    s_waitcnt vmcnt(6)
    buffer_load_dwordx4 v6, s[24:27], s46 offen offset:2048 lds
    ds_read_b64_tr_b16 a[128:129], v21 offset:4096
    ds_read_b64_tr_b16 a[130:131], v21 offset:6144
    s_waitcnt vmcnt(6)
    buffer_load_dwordx4 v7, s[24:27], s46 offen offset:3072 lds
    s_add_u32 m0, m0, 4096
    s_add_u32 s46, s46, 98304
    s_cmp_eq_u32 s46, s48
    s_cselect_b32 s46, s47, s46
    ds_read_b64_tr_b16 a[132:133], v22 offset:4096
    s_waitcnt lgkmcnt(7)
    ds_read_b64_tr_b16 a[134:135], v22 offset:6144
    s_waitcnt vmcnt(6)
    buffer_load_dwordx4 v4, s[24:27], s46 offen offset:0 lds
    ds_read_b64_tr_b16 a[136:137], v23 offset:4096
    ds_read_b64_tr_b16 a[138:139], v23 offset:6144
    s_waitcnt vmcnt(6)
    buffer_load_dwordx4 v5, s[24:27], s46 offen offset:1024 lds
    ds_read_b64_tr_b16 a[140:141], v24 offset:4096
    ds_read_b64_tr_b16 a[142:143], v24 offset:6144
    s_waitcnt vmcnt(6)
    buffer_load_dwordx4 v6, s[24:27], s46 offen offset:2048 lds
    ds_read_b64_tr_b16 a[144:145], v21 offset:8192
    s_waitcnt lgkmcnt(7)
    ds_read_b64_tr_b16 a[146:147], v21 offset:10240
    s_waitcnt vmcnt(6)
    buffer_load_dwordx4 v7, s[24:27], s46 offen offset:3072 lds
    s_add_u32 m0, m0, 4096
    s_add_u32 s46, s46, 98304
    s_cmp_eq_u32 s46, s48
    s_cselect_b32 s46, s47, s46
    ds_read_b64_tr_b16 a[148:149], v22 offset:8192
    ds_read_b64_tr_b16 a[150:151], v22 offset:10240
    s_waitcnt vmcnt(6)
    buffer_load_dwordx4 v4, s[24:27], s46 offen offset:0 lds
    ds_read_b64_tr_b16 a[152:153], v23 offset:8192
    ds_read_b64_tr_b16 a[154:155], v23 offset:10240
    s_waitcnt vmcnt(6)
    buffer_load_dwordx4 v5, s[24:27], s46 offen offset:1024 lds
    ds_read_b64_tr_b16 a[156:157], v24 offset:8192
    s_waitcnt lgkmcnt(7)
    ds_read_b64_tr_b16 a[158:159], v24 offset:10240
    s_waitcnt vmcnt(6)
    buffer_load_dwordx4 v6, s[24:27], s46 offen offset:2048 lds
    ds_read_b64_tr_b16 a[160:161], v21 offset:12288
    ds_read_b64_tr_b16 a[162:163], v21 offset:14336
    s_waitcnt vmcnt(6)
    buffer_load_dwordx4 v7, s[24:27], s46 offen offset:3072 lds
    s_add_u32 m0, m0, 4096
    s_add_u32 s46, s46, 98304
    s_cmp_eq_u32 s46, s48
    s_cselect_b32 s46, s47, s46
    ds_read_b64_tr_b16 a[164:165], v22 offset:12288
    ds_read_b64_tr_b16 a[166:167], v22 offset:14336
    s_waitcnt vmcnt(6)
    buffer_load_dwordx4 v4, s[24:27], s46 offen offset:0 lds
    ds_read_b64_tr_b16 a[168:169], v23 offset:12288
    s_waitcnt lgkmcnt(7)
    ds_read_b64_tr_b16 a[170:171], v23 offset:14336
    s_waitcnt vmcnt(6)
    buffer_load_dwordx4 v5, s[24:27], s46 offen offset:1024 lds
    ds_read_b64_tr_b16 a[172:173], v24 offset:12288
    ds_read_b64_tr_b16 a[174:175], v24 offset:14336
    s_waitcnt vmcnt(6)
    buffer_load_dwordx4 v6, s[24:27], s46 offen offset:2048 lds
    ds_read_b64_tr_b16 a[176:177], v21 offset:16384
    ds_read_b64_tr_b16 a[178:179], v21 offset:18432
    s_waitcnt vmcnt(6)
    buffer_load_dwordx4 v7, s[24:27], s46 offen offset:3072 lds
    s_mov_b32 m0, s41
    s_add_u32 s46, s46, 98304
    s_cmp_eq_u32 s46, s48
    s_cselect_b32 s46, s47, s46
    ds_read_b64_tr_b16 a[180:181], v22 offset:16384
    s_waitcnt lgkmcnt(7)
    ds_read_b64_tr_b16 a[182:183], v22 offset:18432
    s_waitcnt vmcnt(6)
    buffer_load_dwordx4 v4, s[24:27], s46 offen offset:0 lds
    ds_read_b64_tr_b16 a[184:185], v23 offset:16384
    ds_read_b64_tr_b16 a[186:187], v23 offset:18432
    s_waitcnt vmcnt(6)
    buffer_load_dwordx4 v5, s[24:27], s46 offen offset:1024 lds
    ds_read_b64_tr_b16 a[188:189], v24 offset:16384
    ds_read_b64_tr_b16 a[190:191], v24 offset:18432
    global_load_dwordx4 v[60:63], v35, s[18:19] sc1
    s_waitcnt vmcnt(7)
    buffer_load_dwordx4 v6, s[24:27], s46 offen offset:2048 lds
    ds_read_b64_tr_b16 a[192:193], v21 offset:20480
    s_waitcnt lgkmcnt(7)
    ds_read_b64_tr_b16 a[194:195], v21 offset:22528
    s_waitcnt vmcnt(7)
    buffer_load_dwordx4 v7, s[24:27], s46 offen offset:3072 lds
    s_add_u32 m0, m0, 4096
    s_add_u32 s46, s46, 98304
    s_cmp_eq_u32 s46, s48
    s_cselect_b32 s46, s47, s46
    ds_read_b64_tr_b16 a[196:197], v22 offset:20480
    ds_read_b64_tr_b16 a[198:199], v22 offset:22528
    s_waitcnt vmcnt(7)
    buffer_load_dwordx4 v4, s[24:27], s46 offen offset:0 lds
    ds_read_b64_tr_b16 a[200:201], v23 offset:20480
    ds_read_b64_tr_b16 a[202:203], v23 offset:22528
    s_waitcnt vmcnt(7)
    buffer_load_dwordx4 v5, s[24:27], s46 offen offset:1024 lds
    ds_read_b64_tr_b16 a[204:205], v24 offset:20480
    s_waitcnt lgkmcnt(7)
    ds_read_b64_tr_b16 a[206:207], v24 offset:22528
    s_waitcnt vmcnt(7)
    buffer_load_dwordx4 v6, s[24:27], s46 offen offset:2048 lds
    ds_read_b64_tr_b16 a[208:209], v21 offset:24576
    ds_read_b64_tr_b16 a[210:211], v21 offset:26624
    s_waitcnt vmcnt(7)
    buffer_load_dwordx4 v7, s[24:27], s46 offen offset:3072 lds
    ds_read_b64_tr_b16 a[212:213], v22 offset:24576
    ds_read_b64_tr_b16 a[214:215], v22 offset:26624
    s_waitcnt vmcnt(6)
    v_bitop3_b32 v60, v60, v61, v39 bitop3:0x7e
    v_bitop3_b32 v62, v62, v63, v39 bitop3:0x7e
    v_or_b32 v60, v60, v62
    v_cmp_ne_u32 vcc, 0, v60
    s_cbranch_vccz L_ph_ok
    s_mov_b32 s53, 0
L_ph_l:
    global_load_dwordx4 v[60:63], v35, s[18:19] sc1
    s_add_u32 s53, s53, 1
    s_cmp_ge_u32 s53, 400000
    s_cbranch_scc1 L_ph_ok
    s_waitcnt vmcnt(0)
    v_bitop3_b32 v60, v60, v61, v39 bitop3:0x7e
    v_bitop3_b32 v62, v62, v63, v39 bitop3:0x7e
    v_or_b32 v60, v60, v62
    v_cmp_ne_u32 vcc, 0, v60
    s_cbranch_vccnz L_ph_l
L_ph_ok:
    buffer_load_dwordx4 v[144:147], v12, s[32:35], s60 offen sc1
    ds_read_b64_tr_b16 a[216:217], v23 offset:24576
    s_waitcnt lgkmcnt(7)
    ds_read_b64_tr_b16 a[218:219], v23 offset:26624
    buffer_load_dwordx4 v[148:151], v12, s[32:35], s61 offen sc1
    ds_read_b64_tr_b16 a[220:221], v24 offset:24576
    ds_read_b64_tr_b16 a[222:223], v24 offset:26624
    s_waitcnt vmcnt(7)
    buffer_load_dwordx4 v[152:155], v12, s[32:35], s62 offen sc1
    s_waitcnt vmcnt(7)
    buffer_load_dwordx4 v[156:159], v12, s[32:35], s63 offen sc1
    ds_read_b64_tr_b16 a[224:225], v21 offset:0
    ds_read_b64_tr_b16 a[226:227], v21 offset:2048
    s_waitcnt vmcnt(7)
    buffer_load_dwordx4 v[160:163], v12, s[32:35], s64 offen sc1
    ds_read_b64_tr_b16 a[228:229], v22 offset:0
    s_waitcnt lgkmcnt(7)
    ds_read_b64_tr_b16 a[230:231], v22 offset:2048
    s_waitcnt vmcnt(7)
    buffer_load_dwordx4 v[164:167], v12, s[32:35], s65 offen sc1
    ds_read_b64_tr_b16 a[232:233], v23 offset:0
    ds_read_b64_tr_b16 a[234:235], v23 offset:2048
    s_waitcnt vmcnt(7)
    buffer_load_dwordx4 v[168:171], v12, s[32:35], s66 offen sc1
    ds_read_b64_tr_b16 a[236:237], v24 offset:0
    ds_read_b64_tr_b16 a[238:239], v24 offset:2048
    s_waitcnt vmcnt(7)
    buffer_load_dwordx4 v[172:175], v12, s[32:35], s67 offen sc1
    ds_read_b64_tr_b16 a[240:241], v21 offset:4096
    s_waitcnt lgkmcnt(7)
    ds_read_b64_tr_b16 a[242:243], v21 offset:6144
    ds_read_b64_tr_b16 a[244:245], v22 offset:4096
    ds_read_b64_tr_b16 a[246:247], v22 offset:6144
    ds_read_b64_tr_b16 a[248:249], v23 offset:4096
    ds_read_b64_tr_b16 a[250:251], v23 offset:6144
    ds_read_b64_tr_b16 a[252:253], v24 offset:4096
    s_waitcnt lgkmcnt(7)
    ds_read_b64_tr_b16 a[254:255], v24 offset:6144
    s_mul_i32 s47, s40, 1572864
    s_lshl_b32 s50, s45, 7
    s_add_u32 s47, s47, s50
    s_add_u32 s48, s47, 1572864
    s_mov_b32 m0, s41
    s_add_u32 s46, s47, 0
    s_waitcnt lgkmcnt(0)
    s_waitcnt vmcnt(6)
    v_mfma_f32_16x16x32_bf16 v[64:67], a[0:3], v[144:147], 0
    v_mfma_f32_16x16x32_bf16 v[64:67], a[16:19], v[148:151], v[64:67]
    buffer_load_dwordx4 v[176:179], v12, s[32:35], s68 offen sc1
    v_mfma_f32_16x16x32_bf16 v[68:71], a[4:7], v[144:147], 0
    v_mfma_f32_16x16x32_bf16 v[68:71], a[20:23], v[148:151], v[68:71]
    buffer_load_dwordx4 v[180:183], v12, s[32:35], s69 offen sc1
    v_mfma_f32_16x16x32_bf16 v[72:75], a[8:11], v[144:147], 0
    v_mfma_f32_16x16x32_bf16 v[72:75], a[24:27], v[148:151], v[72:75]
    buffer_load_dwordx4 v[184:187], v12, s[32:35], s70 offen sc1
    v_mfma_f32_16x16x32_bf16 v[76:79], a[12:15], v[144:147], 0
    v_mfma_f32_16x16x32_bf16 v[76:79], a[28:31], v[148:151], v[76:79]
    s_waitcnt vmcnt(7)
    v_mfma_f32_16x16x32_bf16 v[64:67], a[32:35], v[152:155], v[64:67]
    v_mfma_f32_16x16x32_bf16 v[64:67], a[48:51], v[156:159], v[64:67]
    buffer_load_dwordx4 v[188:191], v12, s[32:35], s71 offen sc1
    v_mfma_f32_16x16x32_bf16 v[68:71], a[36:39], v[152:155], v[68:71]
    v_mfma_f32_16x16x32_bf16 v[68:71], a[52:55], v[156:159], v[68:71]
    buffer_load_dwordx4 v[192:195], v12, s[32:35], s72 offen sc1
    v_mfma_f32_16x16x32_bf16 v[72:75], a[40:43], v[152:155], v[72:75]
    v_mfma_f32_16x16x32_bf16 v[72:75], a[56:59], v[156:159], v[72:75]
    buffer_load_dwordx4 v[196:199], v12, s[32:35], s73 offen sc1
    v_mfma_f32_16x16x32_bf16 v[76:79], a[44:47], v[152:155], v[76:79]
    v_mfma_f32_16x16x32_bf16 v[76:79], a[60:63], v[156:159], v[76:79]
    s_waitcnt vmcnt(8)
    v_mfma_f32_16x16x32_bf16 v[64:67], a[64:67], v[160:163], v[64:67]
    v_mfma_f32_16x16x32_bf16 v[64:67], a[80:83], v[164:167], v[64:67]
    buffer_load_dwordx4 v[200:203], v12, s[32:35], s74 offen sc1
    v_mfma_f32_16x16x32_bf16 v[68:71], a[68:71], v[160:163], v[68:71]
    v_mfma_f32_16x16x32_bf16 v[68:71], a[84:87], v[164:167], v[68:71]
    buffer_load_dwordx4 v[204:207], v12, s[32:35], s75 offen sc1
    v_mfma_f32_16x16x32_bf16 v[72:75], a[72:75], v[160:163], v[72:75]
    v_mfma_f32_16x16x32_bf16 v[72:75], a[88:91], v[164:167], v[72:75]
    buffer_load_dwordx4 v[144:147], v13, s[32:35], s60 offen sc1
    v_mfma_f32_16x16x32_bf16 v[76:79], a[76:79], v[160:163], v[76:79]
    v_mfma_f32_16x16x32_bf16 v[76:79], a[92:95], v[164:167], v[76:79]
    s_waitcnt vmcnt(9)
    v_mfma_f32_16x16x32_bf16 v[64:67], a[96:99], v[168:171], v[64:67]
    v_mfma_f32_16x16x32_bf16 v[64:67], a[112:115], v[172:175], v[64:67]
    buffer_load_dwordx4 v[148:151], v13, s[32:35], s61 offen sc1
    v_mfma_f32_16x16x32_bf16 v[68:71], a[100:103], v[168:171], v[68:71]
    v_mfma_f32_16x16x32_bf16 v[68:71], a[116:119], v[172:175], v[68:71]
    buffer_load_dwordx4 v[152:155], v13, s[32:35], s62 offen sc1
    v_mfma_f32_16x16x32_bf16 v[72:75], a[104:107], v[168:171], v[72:75]
    v_mfma_f32_16x16x32_bf16 v[72:75], a[120:123], v[172:175], v[72:75]
    buffer_load_dwordx4 v[156:159], v13, s[32:35], s63 offen sc1
    v_mfma_f32_16x16x32_bf16 v[76:79], a[108:111], v[168:171], v[76:79]
    v_mfma_f32_16x16x32_bf16 v[76:79], a[124:127], v[172:175], v[76:79]
    s_waitcnt vmcnt(10)
    v_mfma_f32_16x16x32_bf16 v[64:67], a[128:131], v[176:179], v[64:67]
    v_mfma_f32_16x16x32_bf16 v[64:67], a[144:147], v[180:183], v[64:67]
    buffer_load_dwordx4 v[160:163], v13, s[32:35], s64 offen sc1
    v_mfma_f32_16x16x32_bf16 v[68:71], a[132:135], v[176:179], v[68:71]
    v_mfma_f32_16x16x32_bf16 v[68:71], a[148:151], v[180:183], v[68:71]
    v_mfma_f32_16x16x32_bf16 v[72:75], a[136:139], v[176:179], v[72:75]
    v_mfma_f32_16x16x32_bf16 v[72:75], a[152:155], v[180:183], v[72:75]
    buffer_load_dwordx4 v[164:167], v13, s[32:35], s65 offen sc1
    v_mfma_f32_16x16x32_bf16 v[76:79], a[140:143], v[176:179], v[76:79]
    v_mfma_f32_16x16x32_bf16 v[76:79], a[156:159], v[180:183], v[76:79]
    s_waitcnt vmcnt(10)
    v_mfma_f32_16x16x32_bf16 v[64:67], a[160:163], v[184:187], v[64:67]
    v_mfma_f32_16x16x32_bf16 v[64:67], a[176:179], v[188:191], v[64:67]
    buffer_load_dwordx4 v[168:171], v13, s[32:35], s66 offen sc1
    v_mfma_f32_16x16x32_bf16 v[68:71], a[164:167], v[184:187], v[68:71]
    v_mfma_f32_16x16x32_bf16 v[68:71], a[180:183], v[188:191], v[68:71]
    v_mfma_f32_16x16x32_bf16 v[72:75], a[168:171], v[184:187], v[72:75]
    v_mfma_f32_16x16x32_bf16 v[72:75], a[184:187], v[188:191], v[72:75]
    buffer_load_dwordx4 v[172:175], v13, s[32:35], s67 offen sc1
    v_mfma_f32_16x16x32_bf16 v[76:79], a[172:175], v[184:187], v[76:79]
    v_mfma_f32_16x16x32_bf16 v[76:79], a[188:191], v[188:191], v[76:79]
    s_waitcnt vmcnt(10)
    v_mfma_f32_16x16x32_bf16 v[64:67], a[192:195], v[192:195], v[64:67]
    v_mfma_f32_16x16x32_bf16 v[64:67], a[208:211], v[196:199], v[64:67]
    buffer_load_dwordx4 v[176:179], v13, s[32:35], s68 offen sc1
    v_mfma_f32_16x16x32_bf16 v[68:71], a[196:199], v[192:195], v[68:71]
    v_mfma_f32_16x16x32_bf16 v[68:71], a[212:215], v[196:199], v[68:71]
    v_mfma_f32_16x16x32_bf16 v[72:75], a[200:203], v[192:195], v[72:75]
    v_mfma_f32_16x16x32_bf16 v[72:75], a[216:219], v[196:199], v[72:75]
    buffer_load_dwordx4 v[180:183], v13, s[32:35], s69 offen sc1
    v_mfma_f32_16x16x32_bf16 v[76:79], a[204:207], v[192:195], v[76:79]
    v_mfma_f32_16x16x32_bf16 v[76:79], a[220:223], v[196:199], v[76:79]
    s_waitcnt vmcnt(10)
    v_mfma_f32_16x16x32_bf16 v[64:67], a[224:227], v[200:203], v[64:67]
    v_mfma_f32_16x16x32_bf16 v[64:67], a[240:243], v[204:207], v[64:67]
    buffer_load_dwordx4 v[184:187], v13, s[32:35], s70 offen sc1
    v_mfma_f32_16x16x32_bf16 v[68:71], a[228:231], v[200:203], v[68:71]
    v_mfma_f32_16x16x32_bf16 v[68:71], a[244:247], v[204:207], v[68:71]
    v_mfma_f32_16x16x32_bf16 v[72:75], a[232:235], v[200:203], v[72:75]
    v_mfma_f32_16x16x32_bf16 v[72:75], a[248:251], v[204:207], v[72:75]
    buffer_load_dwordx4 v[188:191], v13, s[32:35], s71 offen sc1
    v_mfma_f32_16x16x32_bf16 v[76:79], a[236:239], v[200:203], v[76:79]
    v_mfma_f32_16x16x32_bf16 v[76:79], a[252:255], v[204:207], v[76:79]
    s_waitcnt vmcnt(10)
    v_mfma_f32_16x16x32_bf16 v[80:83], a[0:3], v[144:147], v[80:83]
    v_mfma_f32_16x16x32_bf16 v[80:83], a[16:19], v[148:151], v[80:83]
    buffer_load_dwordx4 v[192:195], v13, s[32:35], s72 offen sc1
    v_mfma_f32_16x16x32_bf16 v[84:87], a[4:7], v[144:147], v[84:87]
    v_mfma_f32_16x16x32_bf16 v[84:87], a[20:23], v[148:151], v[84:87]
    v_mfma_f32_16x16x32_bf16 v[88:91], a[8:11], v[144:147], 0
    v_mfma_f32_16x16x32_bf16 v[88:91], a[24:27], v[148:151], v[88:91]
    buffer_load_dwordx4 v[196:199], v13, s[32:35], s73 offen sc1
    v_mfma_f32_16x16x32_bf16 v[92:95], a[12:15], v[144:147], 0
    v_mfma_f32_16x16x32_bf16 v[92:95], a[28:31], v[148:151], v[92:95]
    s_waitcnt vmcnt(10)
    v_mfma_f32_16x16x32_bf16 v[80:83], a[32:35], v[152:155], v[80:83]
    ds_write_b128 v29, v[64:67] offset:0
    v_mfma_f32_16x16x32_bf16 v[80:83], a[48:51], v[156:159], v[80:83]
    buffer_load_dwordx4 v[200:203], v13, s[32:35], s74 offen sc1
    v_mfma_f32_16x16x32_bf16 v[84:87], a[36:39], v[152:155], v[84:87]
    v_mfma_f32_16x16x32_bf16 v[84:87], a[52:55], v[156:159], v[84:87]
    ds_write_b128 v29, v[68:71] offset:1024
    v_mfma_f32_16x16x32_bf16 v[88:91], a[40:43], v[152:155], v[88:91]
    v_mfma_f32_16x16x32_bf16 v[88:91], a[56:59], v[156:159], v[88:91]
    buffer_load_dwordx4 v[204:207], v13, s[32:35], s75 offen sc1
    v_mfma_f32_16x16x32_bf16 v[92:95], a[44:47], v[152:155], v[92:95]
    ds_write_b128 v29, v[72:75] offset:2048
    v_mfma_f32_16x16x32_bf16 v[92:95], a[60:63], v[156:159], v[92:95]
    s_waitcnt vmcnt(10)
    v_mfma_f32_16x16x32_bf16 v[80:83], a[64:67], v[160:163], v[80:83]
    ds_write_b128 v29, v[76:79] offset:3072
    v_mfma_f32_16x16x32_bf16 v[80:83], a[80:83], v[164:167], v[80:83]
    buffer_load_dwordx4 v[144:147], v14, s[32:35], s60 offen sc1
    v_mfma_f32_16x16x32_bf16 v[84:87], a[68:71], v[160:163], v[84:87]
    v_mfma_f32_16x16x32_bf16 v[84:87], a[84:87], v[164:167], v[84:87]
    v_mfma_f32_16x16x32_bf16 v[88:91], a[72:75], v[160:163], v[88:91]
    v_mfma_f32_16x16x32_bf16 v[88:91], a[88:91], v[164:167], v[88:91]
    buffer_load_dwordx4 v[148:151], v14, s[32:35], s61 offen sc1
    v_mfma_f32_16x16x32_bf16 v[92:95], a[76:79], v[160:163], v[92:95]
    v_mfma_f32_16x16x32_bf16 v[92:95], a[92:95], v[164:167], v[92:95]
    s_waitcnt vmcnt(10)
    v_mfma_f32_16x16x32_bf16 v[80:83], a[96:99], v[168:171], v[80:83]
    v_mfma_f32_16x16x32_bf16 v[80:83], a[112:115], v[172:175], v[80:83]
    buffer_load_dwordx4 v[152:155], v14, s[32:35], s62 offen sc1
    v_mfma_f32_16x16x32_bf16 v[84:87], a[100:103], v[168:171], v[84:87]
    v_mfma_f32_16x16x32_bf16 v[84:87], a[116:119], v[172:175], v[84:87]
    v_mfma_f32_16x16x32_bf16 v[88:91], a[104:107], v[168:171], v[88:91]
    v_mfma_f32_16x16x32_bf16 v[88:91], a[120:123], v[172:175], v[88:91]
    buffer_load_dwordx4 v[156:159], v14, s[32:35], s63 offen sc1
    v_mfma_f32_16x16x32_bf16 v[92:95], a[108:111], v[168:171], v[92:95]
    v_mfma_f32_16x16x32_bf16 v[92:95], a[124:127], v[172:175], v[92:95]
    s_waitcnt vmcnt(10)
    v_mfma_f32_16x16x32_bf16 v[80:83], a[128:131], v[176:179], v[80:83]
    v_mfma_f32_16x16x32_bf16 v[80:83], a[144:147], v[180:183], v[80:83]
    buffer_load_dwordx4 v[160:163], v14, s[32:35], s64 offen sc1
    v_mfma_f32_16x16x32_bf16 v[84:87], a[132:135], v[176:179], v[84:87]
    v_mfma_f32_16x16x32_bf16 v[84:87], a[148:151], v[180:183], v[84:87]
    v_mfma_f32_16x16x32_bf16 v[88:91], a[136:139], v[176:179], v[88:91]
    v_mfma_f32_16x16x32_bf16 v[88:91], a[152:155], v[180:183], v[88:91]
    buffer_load_dwordx4 v[164:167], v14, s[32:35], s65 offen sc1
    v_mfma_f32_16x16x32_bf16 v[92:95], a[140:143], v[176:179], v[92:95]
    v_mfma_f32_16x16x32_bf16 v[92:95], a[156:159], v[180:183], v[92:95]
    s_waitcnt vmcnt(10)
    v_mfma_f32_16x16x32_bf16 v[80:83], a[160:163], v[184:187], v[80:83]
    v_mfma_f32_16x16x32_bf16 v[80:83], a[176:179], v[188:191], v[80:83]
    buffer_load_dwordx4 v[168:171], v14, s[32:35], s66 offen sc1
    v_mfma_f32_16x16x32_bf16 v[84:87], a[164:167], v[184:187], v[84:87]
    v_mfma_f32_16x16x32_bf16 v[84:87], a[180:183], v[188:191], v[84:87]
    v_mfma_f32_16x16x32_bf16 v[88:91], a[168:171], v[184:187], v[88:91]
    v_mfma_f32_16x16x32_bf16 v[88:91], a[184:187], v[188:191], v[88:91]
    buffer_load_dwordx4 v[172:175], v14, s[32:35], s67 offen sc1
    v_mfma_f32_16x16x32_bf16 v[92:95], a[172:175], v[184:187], v[92:95]
    v_mfma_f32_16x16x32_bf16 v[92:95], a[188:191], v[188:191], v[92:95]
    s_waitcnt vmcnt(10)
    v_mfma_f32_16x16x32_bf16 v[80:83], a[192:195], v[192:195], v[80:83]
    v_mfma_f32_16x16x32_bf16 v[80:83], a[208:211], v[196:199], v[80:83]
    buffer_load_dwordx4 v[176:179], v14, s[32:35], s68 offen sc1
    v_mfma_f32_16x16x32_bf16 v[84:87], a[196:199], v[192:195], v[84:87]
    v_mfma_f32_16x16x32_bf16 v[84:87], a[212:215], v[196:199], v[84:87]
    v_mfma_f32_16x16x32_bf16 v[88:91], a[200:203], v[192:195], v[88:91]
    v_mfma_f32_16x16x32_bf16 v[88:91], a[216:219], v[196:199], v[88:91]
    buffer_load_dwordx4 v[180:183], v14, s[32:35], s69 offen sc1
    v_mfma_f32_16x16x32_bf16 v[92:95], a[204:207], v[192:195], v[92:95]
    v_mfma_f32_16x16x32_bf16 v[92:95], a[220:223], v[196:199], v[92:95]
    s_waitcnt vmcnt(10)
    v_mfma_f32_16x16x32_bf16 v[80:83], a[224:227], v[200:203], v[80:83]
    v_mfma_f32_16x16x32_bf16 v[80:83], a[240:243], v[204:207], v[80:83]
    buffer_load_dwordx4 v[184:187], v14, s[32:35], s70 offen sc1
    v_mfma_f32_16x16x32_bf16 v[84:87], a[228:231], v[200:203], v[84:87]
    v_mfma_f32_16x16x32_bf16 v[84:87], a[244:247], v[204:207], v[84:87]
    v_mfma_f32_16x16x32_bf16 v[88:91], a[232:235], v[200:203], v[88:91]
    v_mfma_f32_16x16x32_bf16 v[88:91], a[248:251], v[204:207], v[88:91]
    buffer_load_dwordx4 v[188:191], v14, s[32:35], s71 offen sc1
    v_mfma_f32_16x16x32_bf16 v[92:95], a[236:239], v[200:203], v[92:95]
    v_mfma_f32_16x16x32_bf16 v[92:95], a[252:255], v[204:207], v[92:95]
    s_waitcnt vmcnt(10)
    v_mfma_f32_16x16x32_bf16 v[96:99], a[0:3], v[144:147], 0
    v_mfma_f32_16x16x32_bf16 v[96:99], a[16:19], v[148:151], v[96:99]
    buffer_load_dwordx4 v[192:195], v14, s[32:35], s72 offen sc1
    v_mfma_f32_16x16x32_bf16 v[100:103], a[4:7], v[144:147], 0
    v_mfma_f32_16x16x32_bf16 v[100:103], a[20:23], v[148:151], v[100:103]
    v_mfma_f32_16x16x32_bf16 v[104:107], a[8:11], v[144:147], 0
    v_mfma_f32_16x16x32_bf16 v[104:107], a[24:27], v[148:151], v[104:107]
    buffer_load_dwordx4 v[196:199], v14, s[32:35], s73 offen sc1
    v_mfma_f32_16x16x32_bf16 v[108:111], a[12:15], v[144:147], 0
    v_mfma_f32_16x16x32_bf16 v[108:111], a[28:31], v[148:151], v[108:111]
    s_waitcnt vmcnt(10)
    v_mfma_f32_16x16x32_bf16 v[96:99], a[32:35], v[152:155], v[96:99]
    ds_write_b128 v29, v[88:91] offset:4096
    v_mfma_f32_16x16x32_bf16 v[96:99], a[48:51], v[156:159], v[96:99]
    buffer_load_dwordx4 v[200:203], v14, s[32:35], s74 offen sc1
    v_mfma_f32_16x16x32_bf16 v[100:103], a[36:39], v[152:155], v[100:103]
    v_mfma_f32_16x16x32_bf16 v[100:103], a[52:55], v[156:159], v[100:103]
    ds_write_b128 v29, v[92:95] offset:5120
    v_mfma_f32_16x16x32_bf16 v[104:107], a[40:43], v[152:155], v[104:107]
    v_mfma_f32_16x16x32_bf16 v[104:107], a[56:59], v[156:159], v[104:107]
    buffer_load_dwordx4 v[204:207], v14, s[32:35], s75 offen sc1
    v_mfma_f32_16x16x32_bf16 v[108:111], a[44:47], v[152:155], v[108:111]
    v_mfma_f32_16x16x32_bf16 v[108:111], a[60:63], v[156:159], v[108:111]
    s_waitcnt vmcnt(10)
    v_mfma_f32_16x16x32_bf16 v[96:99], a[64:67], v[160:163], v[96:99]
    v_mfma_f32_16x16x32_bf16 v[96:99], a[80:83], v[164:167], v[96:99]
    buffer_load_dwordx4 v[144:147], v15, s[32:35], s60 offen sc1
    v_mfma_f32_16x16x32_bf16 v[100:103], a[68:71], v[160:163], v[100:103]
    v_mfma_f32_16x16x32_bf16 v[100:103], a[84:87], v[164:167], v[100:103]
    v_mfma_f32_16x16x32_bf16 v[104:107], a[72:75], v[160:163], v[104:107]
    v_mfma_f32_16x16x32_bf16 v[104:107], a[88:91], v[164:167], v[104:107]
    buffer_load_dwordx4 v[148:151], v15, s[32:35], s61 offen sc1
    v_mfma_f32_16x16x32_bf16 v[108:111], a[76:79], v[160:163], v[108:111]
    v_mfma_f32_16x16x32_bf16 v[108:111], a[92:95], v[164:167], v[108:111]
    s_waitcnt lgkmcnt(0)
    s_barrier
    s_waitcnt vmcnt(10)
    v_mfma_f32_16x16x32_bf16 v[96:99], a[96:99], v[168:171], v[96:99]
    ds_read_b128 v[64:67], v31 offset:0
    ds_read_b128 v[72:75], v32 offset:2048
    v_mfma_f32_16x16x32_bf16 v[96:99], a[112:115], v[172:175], v[96:99]
    buffer_load_dwordx4 v[152:155], v15, s[32:35], s62 offen sc1
    v_mfma_f32_16x16x32_bf16 v[100:103], a[100:103], v[168:171], v[100:103]
    ds_read_b128 v[88:91], v30 offset:4096
    ds_read_b128 v[68:71], v31 offset:1024
    v_mfma_f32_16x16x32_bf16 v[100:103], a[116:119], v[172:175], v[100:103]
    ds_read_b128 v[76:79], v32 offset:3072
    ds_read_b128 v[92:95], v30 offset:5120
    v_mfma_f32_16x16x32_bf16 v[104:107], a[104:107], v[168:171], v[104:107]
    v_mfma_f32_16x16x32_bf16 v[104:107], a[120:123], v[172:175], v[104:107]
    buffer_load_dwordx4 v[156:159], v15, s[32:35], s63 offen sc1
    v_mfma_f32_16x16x32_bf16 v[108:111], a[108:111], v[168:171], v[108:111]
    v_mfma_f32_16x16x32_bf16 v[108:111], a[124:127], v[172:175], v[108:111]
    s_waitcnt vmcnt(10)
    v_mfma_f32_16x16x32_bf16 v[96:99], a[128:131], v[176:179], v[96:99]
    v_mfma_f32_16x16x32_bf16 v[96:99], a[144:147], v[180:183], v[96:99]
    buffer_load_dwordx4 v[160:163], v15, s[32:35], s64 offen sc1
    v_mfma_f32_16x16x32_bf16 v[100:103], a[132:135], v[176:179], v[100:103]
    s_waitcnt lgkmcnt(3)
    v_add_f32 v64, v64, v72
    v_mfma_f32_16x16x32_bf16 v[100:103], a[148:151], v[180:183], v[100:103]
    v_add_f32 v80, v80, v88
    v_add_f32 v65, v65, v73
    v_mfma_f32_16x16x32_bf16 v[104:107], a[136:139], v[176:179], v[104:107]
    v_add_f32 v81, v81, v89
    v_add_f32 v66, v66, v74
    v_mfma_f32_16x16x32_bf16 v[104:107], a[152:155], v[180:183], v[104:107]
    buffer_load_dwordx4 v[164:167], v15, s[32:35], s65 offen sc1
    v_mfma_f32_16x16x32_bf16 v[108:111], a[140:143], v[176:179], v[108:111]
    v_add_f32 v82, v82, v90
    v_add_f32 v67, v67, v75
    v_mfma_f32_16x16x32_bf16 v[108:111], a[156:159], v[180:183], v[108:111]
    v_add_f32 v83, v83, v91
    v_add_f32 v80, v80, v64
    s_waitcnt vmcnt(10)
    v_mfma_f32_16x16x32_bf16 v[96:99], a[160:163], v[184:187], v[96:99]
    v_add_f32 v81, v81, v65
    v_add_f32 v82, v82, v66
    v_mfma_f32_16x16x32_bf16 v[96:99], a[176:179], v[188:191], v[96:99]
    buffer_load_dwordx4 v[168:171], v15, s[32:35], s66 offen sc1
    v_mfma_f32_16x16x32_bf16 v[100:103], a[164:167], v[184:187], v[100:103]
    v_add_f32 v83, v83, v67
    s_waitcnt lgkmcnt(0)
    v_mfma_f32_16x16x32_bf16 v[100:103], a[180:183], v[188:191], v[100:103]
    v_add_f32 v68, v68, v76
    v_add_f32 v84, v84, v92
    v_mfma_f32_16x16x32_bf16 v[104:107], a[168:171], v[184:187], v[104:107]
    v_add_f32 v69, v69, v77
    v_add_f32 v85, v85, v93
    v_mfma_f32_16x16x32_bf16 v[104:107], a[184:187], v[188:191], v[104:107]
    buffer_load_dwordx4 v[172:175], v15, s[32:35], s67 offen sc1
    v_mfma_f32_16x16x32_bf16 v[108:111], a[172:175], v[184:187], v[108:111]
    v_add_f32 v70, v70, v78
    v_add_f32 v86, v86, v94
    v_mfma_f32_16x16x32_bf16 v[108:111], a[188:191], v[188:191], v[108:111]
    v_add_f32 v71, v71, v79
    v_add_f32 v87, v87, v95
    s_waitcnt vmcnt(10)
    v_mfma_f32_16x16x32_bf16 v[96:99], a[192:195], v[192:195], v[96:99]
    v_add_f32 v84, v84, v68
    v_add_f32 v85, v85, v69
    v_mfma_f32_16x16x32_bf16 v[96:99], a[208:211], v[196:199], v[96:99]
    buffer_load_dwordx4 v[176:179], v15, s[32:35], s68 offen sc1
    v_mfma_f32_16x16x32_bf16 v[100:103], a[196:199], v[192:195], v[100:103]
    v_add_f32 v86, v86, v70
    v_add_f32 v87, v87, v71
    v_mfma_f32_16x16x32_bf16 v[100:103], a[212:215], v[196:199], v[100:103]
    v_mul_f32 v208, v80, v80
    v_mul_f32 v209, v81, v81
    v_mfma_f32_16x16x32_bf16 v[104:107], a[200:203], v[192:195], v[104:107]
    v_mul_f32 v210, v82, v82
    v_mul_f32 v211, v83, v83
    v_mfma_f32_16x16x32_bf16 v[104:107], a[216:219], v[196:199], v[104:107]
    buffer_load_dwordx4 v[180:183], v15, s[32:35], s69 offen sc1
    v_mfma_f32_16x16x32_bf16 v[108:111], a[204:207], v[192:195], v[108:111]
    v_mul_f32 v212, v84, v84
    v_mul_f32 v213, v85, v85
    v_mfma_f32_16x16x32_bf16 v[108:111], a[220:223], v[196:199], v[108:111]
    v_mul_f32 v214, v86, v86
    v_mul_f32 v215, v87, v87
    s_waitcnt vmcnt(10)
    v_mfma_f32_16x16x32_bf16 v[96:99], a[224:227], v[200:203], v[96:99]
    v_fma_f32 v208, v208, v51, v50
    v_fma_f32 v209, v209, v51, v50
    v_mfma_f32_16x16x32_bf16 v[96:99], a[240:243], v[204:207], v[96:99]
    buffer_load_dwordx4 v[184:187], v15, s[32:35], s70 offen sc1
    v_mfma_f32_16x16x32_bf16 v[100:103], a[228:231], v[200:203], v[100:103]
    v_fma_f32 v210, v210, v51, v50
    v_fma_f32 v211, v211, v51, v50
    v_mfma_f32_16x16x32_bf16 v[100:103], a[244:247], v[204:207], v[100:103]
    v_fma_f32 v212, v212, v51, v50
    v_fma_f32 v213, v213, v51, v50
    v_mfma_f32_16x16x32_bf16 v[104:107], a[232:235], v[200:203], v[104:107]
    v_fma_f32 v214, v214, v51, v50
    v_fma_f32 v215, v215, v51, v50
    v_mfma_f32_16x16x32_bf16 v[104:107], a[248:251], v[204:207], v[104:107]
    buffer_load_dwordx4 v[188:191], v15, s[32:35], s71 offen sc1
    v_mfma_f32_16x16x32_bf16 v[108:111], a[236:239], v[200:203], v[108:111]
    v_mul_f32 v208, v208, v80
    v_mul_f32 v209, v209, v81
    v_mfma_f32_16x16x32_bf16 v[108:111], a[252:255], v[204:207], v[108:111]
    v_mul_f32 v210, v210, v82
    v_mul_f32 v211, v211, v83
    s_waitcnt vmcnt(10)
    v_mfma_f32_16x16x32_bf16 v[112:115], a[0:3], v[144:147], v[112:115]
    v_mul_f32 v212, v212, v84
    v_mul_f32 v213, v213, v85
    v_mfma_f32_16x16x32_bf16 v[112:115], a[16:19], v[148:151], v[112:115]
    buffer_load_dwordx4 v[192:195], v15, s[32:35], s72 offen sc1
    v_mfma_f32_16x16x32_bf16 v[116:119], a[4:7], v[144:147], v[116:119]
    v_mul_f32 v214, v214, v86
    v_mul_f32 v215, v215, v87
    v_mfma_f32_16x16x32_bf16 v[116:119], a[20:23], v[148:151], v[116:119]
    v_exp_f32 v208, v208
    v_mfma_f32_16x16x32_bf16 v[120:123], a[8:11], v[144:147], 0
    v_exp_f32 v209, v209
    v_mfma_f32_16x16x32_bf16 v[120:123], a[24:27], v[148:151], v[120:123]
    buffer_load_dwordx4 v[196:199], v15, s[32:35], s73 offen sc1
    v_mfma_f32_16x16x32_bf16 v[124:127], a[12:15], v[144:147], 0
    v_exp_f32 v210, v210
    v_mfma_f32_16x16x32_bf16 v[124:127], a[28:31], v[148:151], v[124:127]
    v_exp_f32 v211, v211
    s_waitcnt vmcnt(10)
    v_mfma_f32_16x16x32_bf16 v[112:115], a[32:35], v[152:155], v[112:115]
    v_exp_f32 v212, v212
    v_mfma_f32_16x16x32_bf16 v[112:115], a[48:51], v[156:159], v[112:115]
    buffer_load_dwordx4 v[200:203], v15, s[32:35], s74 offen sc1
    v_mfma_f32_16x16x32_bf16 v[116:119], a[36:39], v[152:155], v[116:119]
    v_exp_f32 v213, v213
    v_mfma_f32_16x16x32_bf16 v[116:119], a[52:55], v[156:159], v[116:119]
    v_exp_f32 v214, v214
    v_mfma_f32_16x16x32_bf16 v[120:123], a[40:43], v[152:155], v[120:123]
    v_exp_f32 v215, v215
    v_mfma_f32_16x16x32_bf16 v[120:123], a[56:59], v[156:159], v[120:123]
    buffer_load_dwordx4 v[204:207], v15, s[32:35], s75 offen sc1
    v_mfma_f32_16x16x32_bf16 v[124:127], a[44:47], v[152:155], v[124:127]
    v_add_f32 v208, 1.0, v208
    v_add_f32 v209, 1.0, v209
    v_mfma_f32_16x16x32_bf16 v[124:127], a[60:63], v[156:159], v[124:127]
    v_add_f32 v210, 1.0, v210
    v_add_f32 v211, 1.0, v211
    s_waitcnt vmcnt(10)
    v_mfma_f32_16x16x32_bf16 v[112:115], a[64:67], v[160:163], v[112:115]
    v_add_f32 v212, 1.0, v212
    v_add_f32 v213, 1.0, v213
    v_mfma_f32_16x16x32_bf16 v[112:115], a[80:83], v[164:167], v[112:115]
    buffer_load_dwordx4 v8, s[28:31], s46 offen offset:0 lds
    v_mfma_f32_16x16x32_bf16 v[116:119], a[68:71], v[160:163], v[116:119]
    v_add_f32 v214, 1.0, v214
    v_add_f32 v215, 1.0, v215
    v_mfma_f32_16x16x32_bf16 v[116:119], a[84:87], v[164:167], v[116:119]
    v_rcp_f32 v208, v208
    v_mfma_f32_16x16x32_bf16 v[120:123], a[72:75], v[160:163], v[120:123]
    v_rcp_f32 v209, v209
    v_mfma_f32_16x16x32_bf16 v[120:123], a[88:91], v[164:167], v[120:123]
    buffer_load_dwordx4 v9, s[28:31], s46 offen offset:1024 lds
    v_mfma_f32_16x16x32_bf16 v[124:127], a[76:79], v[160:163], v[124:127]
    v_rcp_f32 v210, v210
    v_mfma_f32_16x16x32_bf16 v[124:127], a[92:95], v[164:167], v[124:127]
    v_rcp_f32 v211, v211
    s_waitcnt vmcnt(10)
    v_mfma_f32_16x16x32_bf16 v[112:115], a[96:99], v[168:171], v[112:115]
    v_rcp_f32 v212, v212
    v_mfma_f32_16x16x32_bf16 v[112:115], a[112:115], v[172:175], v[112:115]
    buffer_load_dwordx4 v10, s[28:31], s46 offen offset:2048 lds
    v_mfma_f32_16x16x32_bf16 v[116:119], a[100:103], v[168:171], v[116:119]
    v_rcp_f32 v213, v213
    v_mfma_f32_16x16x32_bf16 v[116:119], a[116:119], v[172:175], v[116:119]
    v_rcp_f32 v214, v214
    v_mfma_f32_16x16x32_bf16 v[120:123], a[104:107], v[168:171], v[120:123]
    v_rcp_f32 v215, v215
    v_mfma_f32_16x16x32_bf16 v[120:123], a[120:123], v[172:175], v[120:123]
    buffer_load_dwordx4 v11, s[28:31], s46 offen offset:3072 lds
    s_add_u32 m0, m0, 4096
    s_add_u32 s46, s47, 131072
    v_mfma_f32_16x16x32_bf16 v[124:127], a[108:111], v[168:171], v[124:127]
    v_mul_f32 v208, v208, v80
    v_mul_f32 v209, v209, v81
    v_mfma_f32_16x16x32_bf16 v[124:127], a[124:127], v[172:175], v[124:127]
    v_mul_f32 v210, v210, v82
    v_mul_f32 v211, v211, v83
    s_waitcnt vmcnt(10)
    v_mfma_f32_16x16x32_bf16 v[112:115], a[128:131], v[176:179], v[112:115]
    v_mul_f32 v212, v212, v84
    v_mul_f32 v213, v213, v85
    v_mfma_f32_16x16x32_bf16 v[112:115], a[144:147], v[180:183], v[112:115]
    buffer_load_dwordx4 v8, s[28:31], s46 offen offset:0 lds
    v_mfma_f32_16x16x32_bf16 v[116:119], a[132:135], v[176:179], v[116:119]
    v_mul_f32 v214, v214, v86
    v_mul_f32 v215, v215, v87
    v_mfma_f32_16x16x32_bf16 v[116:119], a[148:151], v[180:183], v[116:119]
    v_cvt_pk_bf16_f32 v216, v208, v209
    v_cvt_pk_bf16_f32 v217, v210, v211
    v_mfma_f32_16x16x32_bf16 v[120:123], a[136:139], v[176:179], v[120:123]
    v_cvt_pk_bf16_f32 v218, v212, v213
    v_cvt_pk_bf16_f32 v219, v214, v215
    v_mfma_f32_16x16x32_bf16 v[120:123], a[152:155], v[180:183], v[120:123]
    buffer_load_dwordx4 v9, s[28:31], s46 offen offset:1024 lds
    v_mfma_f32_16x16x32_bf16 v[124:127], a[140:143], v[176:179], v[124:127]
    buffer_store_dwordx4 v[216:219], v16, s[32:35], s49 offen sc1
    v_mfma_f32_16x16x32_bf16 v[124:127], a[156:159], v[180:183], v[124:127]
    ds_write_b128 v29, v[96:99] offset:6144
    s_waitcnt vmcnt(11)
    v_mfma_f32_16x16x32_bf16 v[112:115], a[160:163], v[184:187], v[112:115]
    v_mfma_f32_16x16x32_bf16 v[112:115], a[176:179], v[188:191], v[112:115]
    buffer_load_dwordx4 v10, s[28:31], s46 offen offset:2048 lds
    v_mfma_f32_16x16x32_bf16 v[116:119], a[164:167], v[184:187], v[116:119]
    ds_write_b128 v29, v[100:103] offset:7168
    v_mfma_f32_16x16x32_bf16 v[116:119], a[180:183], v[188:191], v[116:119]
    v_mfma_f32_16x16x32_bf16 v[120:123], a[168:171], v[184:187], v[120:123]
    ds_write_b128 v29, v[104:107] offset:8192
    v_mfma_f32_16x16x32_bf16 v[120:123], a[184:187], v[188:191], v[120:123]
    buffer_load_dwordx4 v11, s[28:31], s46 offen offset:3072 lds
    s_add_u32 m0, m0, 4096
    s_add_u32 s46, s47, 262144
    v_mfma_f32_16x16x32_bf16 v[124:127], a[172:175], v[184:187], v[124:127]
    v_mfma_f32_16x16x32_bf16 v[124:127], a[188:191], v[188:191], v[124:127]
    ds_write_b128 v29, v[108:111] offset:9216
    s_waitcnt vmcnt(11)
    v_mfma_f32_16x16x32_bf16 v[112:115], a[192:195], v[192:195], v[112:115]
    v_mfma_f32_16x16x32_bf16 v[112:115], a[208:211], v[196:199], v[112:115]
    buffer_load_dwordx4 v8, s[28:31], s46 offen offset:0 lds
    v_mfma_f32_16x16x32_bf16 v[116:119], a[196:199], v[192:195], v[116:119]
    v_mfma_f32_16x16x32_bf16 v[116:119], a[212:215], v[196:199], v[116:119]
    v_mfma_f32_16x16x32_bf16 v[120:123], a[200:203], v[192:195], v[120:123]
    v_mfma_f32_16x16x32_bf16 v[120:123], a[216:219], v[196:199], v[120:123]
    buffer_load_dwordx4 v9, s[28:31], s46 offen offset:1024 lds
    v_mfma_f32_16x16x32_bf16 v[124:127], a[204:207], v[192:195], v[124:127]
    v_mfma_f32_16x16x32_bf16 v[124:127], a[220:223], v[196:199], v[124:127]
    s_waitcnt vmcnt(11)
    v_mfma_f32_16x16x32_bf16 v[120:123], a[232:235], v[200:203], v[120:123]
    v_mfma_f32_16x16x32_bf16 v[120:123], a[248:251], v[204:207], v[120:123]
    buffer_load_dwordx4 v10, s[28:31], s46 offen offset:2048 lds
    v_mfma_f32_16x16x32_bf16 v[124:127], a[236:239], v[200:203], v[124:127]
    v_mfma_f32_16x16x32_bf16 v[124:127], a[252:255], v[204:207], v[124:127]
    v_mfma_f32_16x16x32_bf16 v[112:115], a[224:227], v[200:203], v[112:115]
    v_mfma_f32_16x16x32_bf16 v[112:115], a[240:243], v[204:207], v[112:115]
    buffer_load_dwordx4 v11, s[28:31], s46 offen offset:3072 lds
    s_add_u32 m0, m0, 4096
    s_add_u32 s46, s55, 0
    s_and_b32 s46, s46, 7
    s_add_u32 s46, s46, 4
    s_lshl_b32 s46, s46, 17
    s_add_u32 s46, s46, s47
    v_mfma_f32_16x16x32_bf16 v[116:119], a[228:231], v[200:203], v[116:119]
    v_mfma_f32_16x16x32_bf16 v[116:119], a[244:247], v[204:207], v[116:119]
    s_nop 3
    ds_write_b128 v29, v[120:123] offset:10240
    ds_write_b128 v29, v[124:127] offset:11264
    buffer_load_dwordx4 v8, s[28:31], s46 offen offset:0 lds
    s_waitcnt lgkmcnt(0)
    s_barrier
    ds_read_b128 v[96:99], v31 offset:6144
    ds_read_b128 v[104:107], v32 offset:8192
    ds_read_b128 v[120:123], v30 offset:10240
    ds_read_b128 v[100:103], v31 offset:7168
    ds_read_b128 v[108:111], v32 offset:9216
    ds_read_b128 v[124:127], v30 offset:11264
    buffer_load_dwordx4 v9, s[28:31], s46 offen offset:1024 lds
    s_waitcnt lgkmcnt(3)
    v_add_f32 v96, v96, v104
    v_add_f32 v112, v112, v120
    v_add_f32 v97, v97, v105
    v_add_f32 v113, v113, v121
    v_add_f32 v98, v98, v106
    v_add_f32 v114, v114, v122
    v_add_f32 v99, v99, v107
    buffer_load_dwordx4 v10, s[28:31], s46 offen offset:2048 lds
    v_add_f32 v115, v115, v123
    v_add_f32 v112, v112, v96
    v_add_f32 v113, v113, v97
    v_add_f32 v114, v114, v98
    v_add_f32 v115, v115, v99
    s_waitcnt lgkmcnt(0)
    v_add_f32 v100, v100, v108
    v_add_f32 v116, v116, v124
    buffer_load_dwordx4 v11, s[28:31], s46 offen offset:3072 lds
    s_add_u32 m0, m0, 4096
    s_add_u32 s46, s47, 393216
    v_add_f32 v101, v101, v109
    v_add_f32 v117, v117, v125
    v_add_f32 v102, v102, v110
    v_add_f32 v118, v118, v126
    v_add_f32 v103, v103, v111
    v_add_f32 v119, v119, v127
    v_add_f32 v116, v116, v100
    v_add_f32 v117, v117, v101
    buffer_load_dwordx4 v8, s[28:31], s46 offen offset:0 lds
    v_add_f32 v118, v118, v102
    v_add_f32 v119, v119, v103
    v_mul_f32 v220, v112, v112
    v_mul_f32 v221, v113, v113
    v_mul_f32 v222, v114, v114
    v_mul_f32 v223, v115, v115
    v_mul_f32 v224, v116, v116
    v_mul_f32 v225, v117, v117
    s_waitcnt vmcnt(11)
    s_atomic_add s1, s[4:5], s17
    buffer_load_dwordx4 v9, s[28:31], s46 offen offset:1024 lds
    ds_read_b64_tr_b16 a[0:1], v25 offset:0
    ds_read_b64_tr_b16 a[2:3], v25 offset:2048
    v_mul_f32 v226, v118, v118
    v_mul_f32 v227, v119, v119
    v_fma_f32 v220, v220, v51, v50
    v_fma_f32 v221, v221, v51, v50
    v_fma_f32 v222, v222, v51, v50
    v_fma_f32 v223, v223, v51, v50
    v_fma_f32 v224, v224, v51, v50
    v_fma_f32 v225, v225, v51, v50
    v_fma_f32 v226, v226, v51, v50
    v_fma_f32 v227, v227, v51, v50
    v_mul_f32 v220, v220, v112
    v_mul_f32 v221, v221, v113
    v_mul_f32 v222, v222, v114
    v_mul_f32 v223, v223, v115
    v_mul_f32 v224, v224, v116
    v_mul_f32 v225, v225, v117
    v_mul_f32 v226, v226, v118
    v_mul_f32 v227, v227, v119
    v_exp_f32 v220, v220
    v_exp_f32 v221, v221
    v_exp_f32 v222, v222
    v_exp_f32 v223, v223
    v_exp_f32 v224, v224
    v_exp_f32 v225, v225
    v_exp_f32 v226, v226
    v_exp_f32 v227, v227
    v_add_f32 v220, 1.0, v220
    v_add_f32 v221, 1.0, v221
    v_add_f32 v222, 1.0, v222
    v_add_f32 v223, 1.0, v223
    v_add_f32 v224, 1.0, v224
    v_add_f32 v225, 1.0, v225
    v_add_f32 v226, 1.0, v226
    v_add_f32 v227, 1.0, v227
    v_rcp_f32 v220, v220
    v_rcp_f32 v221, v221
    v_rcp_f32 v222, v222
    v_rcp_f32 v223, v223
    v_rcp_f32 v224, v224
    v_rcp_f32 v225, v225
    v_rcp_f32 v226, v226
    v_rcp_f32 v227, v227
    v_mul_f32 v220, v220, v112
    v_mul_f32 v221, v221, v113
    v_mul_f32 v222, v222, v114
    v_mul_f32 v223, v223, v115
    v_mul_f32 v224, v224, v116
    v_mul_f32 v225, v225, v117
    v_mul_f32 v226, v226, v118
    v_mul_f32 v227, v227, v119
    v_cvt_pk_bf16_f32 v228, v220, v221
    v_cvt_pk_bf16_f32 v229, v222, v223
    v_cvt_pk_bf16_f32 v230, v224, v225
    v_cvt_pk_bf16_f32 v231, v226, v227
    buffer_store_dwordx4 v[228:231], v16, s[32:35], s52 offen sc1
    s_waitcnt vmcnt(7)
    buffer_load_dwordx4 v10, s[28:31], s46 offen offset:2048 lds
    ds_read_b64_tr_b16 a[4:5], v26 offset:0
    ds_read_b64_tr_b16 a[6:7], v26 offset:2048
    ds_read_b64_tr_b16 a[8:9], v27 offset:0
    ds_read_b64_tr_b16 a[10:11], v27 offset:2048
    s_waitcnt vmcnt(7)
    buffer_load_dwordx4 v11, s[28:31], s46 offen offset:3072 lds
    s_add_u32 m0, m0, 4096
    s_add_u32 s46, s55, 1
    s_and_b32 s46, s46, 7
    s_add_u32 s46, s46, 4
    s_lshl_b32 s46, s46, 17
    s_add_u32 s46, s46, s47
    ds_read_b64_tr_b16 a[12:13], v28 offset:0
    ds_read_b64_tr_b16 a[14:15], v28 offset:2048
    ds_read_b64_tr_b16 a[16:17], v25 offset:4096
    ds_read_b64_tr_b16 a[18:19], v25 offset:6144
    s_waitcnt vmcnt(7)
    buffer_load_dwordx4 v8, s[28:31], s46 offen offset:0 lds
    ds_read_b64_tr_b16 a[20:21], v26 offset:4096
    ds_read_b64_tr_b16 a[22:23], v26 offset:6144
    ds_read_b64_tr_b16 a[24:25], v27 offset:4096
    s_waitcnt lgkmcnt(7)
    ds_read_b64_tr_b16 a[26:27], v27 offset:6144
    s_waitcnt vmcnt(7)
    buffer_load_dwordx4 v9, s[28:31], s46 offen offset:1024 lds
    ds_read_b64_tr_b16 a[28:29], v28 offset:4096
    ds_read_b64_tr_b16 a[30:31], v28 offset:6144
    ds_read_b64_tr_b16 a[32:33], v25 offset:8192
    ds_read_b64_tr_b16 a[34:35], v25 offset:10240
    s_waitcnt vmcnt(7)
    buffer_load_dwordx4 v10, s[28:31], s46 offen offset:2048 lds
    ds_read_b64_tr_b16 a[36:37], v26 offset:8192
    s_waitcnt lgkmcnt(7)
    ds_read_b64_tr_b16 a[38:39], v26 offset:10240
    ds_read_b64_tr_b16 a[40:41], v27 offset:8192
    ds_read_b64_tr_b16 a[42:43], v27 offset:10240
    s_waitcnt vmcnt(7)
    buffer_load_dwordx4 v11, s[28:31], s46 offen offset:3072 lds
    s_add_u32 m0, m0, 4096
    s_add_u32 s46, s55, 2
    s_and_b32 s46, s46, 7
    s_add_u32 s46, s46, 4
    s_lshl_b32 s46, s46, 17
    s_add_u32 s46, s46, s47
    ds_read_b64_tr_b16 a[44:45], v28 offset:8192
    ds_read_b64_tr_b16 a[46:47], v28 offset:10240
    ds_read_b64_tr_b16 a[48:49], v25 offset:12288
    s_waitcnt lgkmcnt(7)
    ds_read_b64_tr_b16 a[50:51], v25 offset:14336
    s_waitcnt vmcnt(7)
    buffer_load_dwordx4 v8, s[28:31], s46 offen offset:0 lds
    ds_read_b64_tr_b16 a[52:53], v26 offset:12288
    ds_read_b64_tr_b16 a[54:55], v26 offset:14336
    s_waitcnt vmcnt(7)
    s_atomic_add s59, s[4:5], s58
    s_or_b32 s50, s2, s40
    s_cbranch_scc1 L_join
    s_atomic_add s20, s[4:5], 16384
L_join:
    s_waitcnt vmcnt(6)
    buffer_load_dwordx4 v9, s[28:31], s46 offen offset:1024 lds
    ds_read_b64_tr_b16 a[56:57], v27 offset:12288
    ds_read_b64_tr_b16 a[58:59], v27 offset:14336
    s_mul_i32 s56, s44, 491520
    s_mul_i32 s51, s40, 24576
    s_add_u32 s56, s56, s51
    s_add_u32 s56, s56, 5373952
    s_add_u32 s60, s56, 0
    s_add_u32 s61, s56, 2048
    s_add_u32 s62, s56, 4096
    s_add_u32 s63, s55, 0
    s_and_b32 s63, s63, 7
    s_add_u32 s63, s63, 4
    s_lshl_b32 s63, s63, 11
    s_add_u32 s63, s63, s56
    s_waitcnt vmcnt(6)
    buffer_load_dwordx4 v10, s[28:31], s46 offen offset:2048 lds
    ds_read_b64_tr_b16 a[60:61], v28 offset:12288
    s_waitcnt lgkmcnt(7)
    ds_read_b64_tr_b16 a[62:63], v28 offset:14336
    ds_read_b64_tr_b16 a[64:65], v25 offset:16384
    ds_read_b64_tr_b16 a[66:67], v25 offset:18432
    s_add_u32 s64, s56, 6144
    s_add_u32 s65, s55, 1
    s_and_b32 s65, s65, 7
    s_add_u32 s65, s65, 4
    s_lshl_b32 s65, s65, 11
    s_add_u32 s65, s65, s56
    s_add_u32 s66, s55, 2
    s_and_b32 s66, s66, 7
    s_add_u32 s66, s66, 4
    s_lshl_b32 s66, s66, 11
    s_add_u32 s66, s66, s56
    s_waitcnt vmcnt(6)
    buffer_load_dwordx4 v11, s[28:31], s46 offen offset:3072 lds
    s_mov_b32 m0, s41
    s_add_u32 s46, s55, 3
    s_and_b32 s46, s46, 7
    s_add_u32 s46, s46, 4
    s_lshl_b32 s46, s46, 17
    s_add_u32 s46, s46, s47
    ds_read_b64_tr_b16 a[68:69], v26 offset:16384
    ds_read_b64_tr_b16 a[70:71], v26 offset:18432
    s_add_u32 s67, s55, 3
    s_and_b32 s67, s67, 7
    s_add_u32 s67, s67, 4
    s_lshl_b32 s67, s67, 11
    s_add_u32 s67, s67, s56
    s_add_u32 s68, s55, 4
    s_and_b32 s68, s68, 7
    s_add_u32 s68, s68, 4
    s_lshl_b32 s68, s68, 11
    s_add_u32 s68, s68, s56
    s_waitcnt vmcnt(6)
    buffer_load_dwordx4 v8, s[28:31], s46 offen offset:0 lds
    ds_read_b64_tr_b16 a[72:73], v27 offset:16384
    s_waitcnt lgkmcnt(7)
    ds_read_b64_tr_b16 a[74:75], v27 offset:18432
    s_add_u32 s69, s55, 5
    s_and_b32 s69, s69, 7
    s_add_u32 s69, s69, 4
    s_lshl_b32 s69, s69, 11
    s_add_u32 s69, s69, s56
    s_add_u32 s70, s55, 6
    s_and_b32 s70, s70, 7
    s_add_u32 s70, s70, 4
    s_lshl_b32 s70, s70, 11
    s_add_u32 s70, s70, s56
    s_waitcnt vmcnt(6)
    buffer_load_dwordx4 v9, s[28:31], s46 offen offset:1024 lds
    ds_read_b64_tr_b16 a[76:77], v28 offset:16384
    ds_read_b64_tr_b16 a[78:79], v28 offset:18432
    s_add_u32 s71, s55, 7
    s_and_b32 s71, s71, 7
    s_add_u32 s71, s71, 4
    s_lshl_b32 s71, s71, 11
    s_add_u32 s71, s71, s56
    v_lshlrev_b32 v44, 16, v44
    v_mov_b32 v64, v44
    v_mov_b32 v65, v44
    s_waitcnt vmcnt(6)
    buffer_load_dwordx4 v10, s[28:31], s46 offen offset:2048 lds
    ds_read_b64_tr_b16 a[80:81], v25 offset:20480
    ds_read_b64_tr_b16 a[82:83], v25 offset:22528
    v_mov_b32 v66, v44
    v_mov_b32 v67, v44
    v_mov_b32 v80, v44
    v_mov_b32 v81, v44
    v_mov_b32 v82, v44
    v_mov_b32 v83, v44
    v_mov_b32 v96, v44
    v_mov_b32 v97, v44
    s_waitcnt vmcnt(6)
    buffer_load_dwordx4 v11, s[28:31], s46 offen offset:3072 lds
    s_add_u32 m0, m0, 4096
    s_add_u32 s46, s55, 4
    s_and_b32 s46, s46, 7
    s_add_u32 s46, s46, 4
    s_lshl_b32 s46, s46, 17
    s_add_u32 s46, s46, s47
    ds_read_b64_tr_b16 a[84:85], v26 offset:20480
    s_waitcnt lgkmcnt(7)
    ds_read_b64_tr_b16 a[86:87], v26 offset:22528
    v_mov_b32 v98, v44
    v_mov_b32 v99, v44
    v_mov_b32 v112, v44
    v_mov_b32 v113, v44
    v_mov_b32 v114, v44
    v_mov_b32 v115, v44
    v_mov_b32 v128, v44
    v_mov_b32 v129, v44
    s_waitcnt vmcnt(6)
    buffer_load_dwordx4 v8, s[28:31], s46 offen offset:0 lds
    ds_read_b64_tr_b16 a[88:89], v27 offset:20480
    ds_read_b64_tr_b16 a[90:91], v27 offset:22528
    v_mov_b32 v130, v44
    v_mov_b32 v131, v44
    s_xor_b32 s50, s40, 0
    s_mul_i32 s50, s50, 28672
    v_add_u32 v29, s50, v52
    s_xor_b32 s50, s40, 1
    s_mul_i32 s50, s50, 28672
    v_add_u32 v30, s50, v52
    s_waitcnt vmcnt(6)
    buffer_load_dwordx4 v9, s[28:31], s46 offen offset:1024 lds
    ds_read_b64_tr_b16 a[92:93], v28 offset:20480
    ds_read_b64_tr_b16 a[94:95], v28 offset:22528
    s_xor_b32 s50, s40, 2
    s_mul_i32 s50, s50, 28672
    v_add_u32 v31, s50, v52
    s_xor_b32 s50, s40, 3
    s_mul_i32 s50, s50, 28672
    v_add_u32 v32, s50, v52
    s_lshl_b32 s49, s44, 7
    s_lshl_b32 s56, s44, 5
    s_add_u32 s56, s56, 1024
    s_waitcnt vmcnt(6)
    buffer_load_dwordx4 v10, s[28:31], s46 offen offset:2048 lds
    ds_read_b64_tr_b16 a[96:97], v25 offset:24576
    s_waitcnt lgkmcnt(7)
    ds_read_b64_tr_b16 a[98:99], v25 offset:26624
    s_waitcnt vmcnt(6)
    buffer_load_dwordx4 v11, s[28:31], s46 offen offset:3072 lds
    s_add_u32 m0, m0, 4096
    s_add_u32 s46, s55, 5
    s_and_b32 s46, s46, 7
    s_add_u32 s46, s46, 4
    s_lshl_b32 s46, s46, 17
    s_add_u32 s46, s46, s47
    ds_read_b64_tr_b16 a[100:101], v26 offset:24576
    ds_read_b64_tr_b16 a[102:103], v26 offset:26624
    s_waitcnt vmcnt(6)
    buffer_load_dwordx4 v8, s[28:31], s46 offen offset:0 lds
    ds_read_b64_tr_b16 a[104:105], v27 offset:24576
    ds_read_b64_tr_b16 a[106:107], v27 offset:26624
    s_waitcnt vmcnt(6)
    buffer_load_dwordx4 v9, s[28:31], s46 offen offset:1024 lds
    ds_read_b64_tr_b16 a[108:109], v28 offset:24576
    s_waitcnt lgkmcnt(7)
    ds_read_b64_tr_b16 a[110:111], v28 offset:26624
    s_waitcnt vmcnt(6)
    buffer_load_dwordx4 v10, s[28:31], s46 offen offset:2048 lds
    ds_read_b64_tr_b16 a[112:113], v25 offset:0
    ds_read_b64_tr_b16 a[114:115], v25 offset:2048
    s_waitcnt vmcnt(6)
    buffer_load_dwordx4 v11, s[28:31], s46 offen offset:3072 lds
    s_add_u32 m0, m0, 4096
    s_add_u32 s46, s55, 6
    s_and_b32 s46, s46, 7
    s_add_u32 s46, s46, 4
    s_lshl_b32 s46, s46, 17
    s_add_u32 s46, s46, s47
    ds_read_b64_tr_b16 a[116:117], v26 offset:0
    ds_read_b64_tr_b16 a[118:119], v26 offset:2048
    s_waitcnt vmcnt(6)
    buffer_load_dwordx4 v8, s[28:31], s46 offen offset:0 lds
    ds_read_b64_tr_b16 a[120:121], v27 offset:0
    s_waitcnt lgkmcnt(7)
    ds_read_b64_tr_b16 a[122:123], v27 offset:2048
    s_waitcnt vmcnt(6)
    buffer_load_dwordx4 v9, s[28:31], s46 offen offset:1024 lds
    ds_read_b64_tr_b16 a[124:125], v28 offset:0
    ds_read_b64_tr_b16 a[126:127], v28 offset:2048
    global_load_dword v60, v36, s[18:19] sc1
    s_waitcnt vmcnt(7)
    buffer_load_dwordx4 v10, s[28:31], s46 offen offset:2048 lds
    ds_read_b64_tr_b16 a[128:129], v25 offset:4096
    ds_read_b64_tr_b16 a[130:131], v25 offset:6144
    s_waitcnt vmcnt(7)
    buffer_load_dwordx4 v11, s[28:31], s46 offen offset:3072 lds
    s_add_u32 m0, m0, 4096
    s_add_u32 s46, s55, 7
    s_and_b32 s46, s46, 7
    s_add_u32 s46, s46, 4
    s_lshl_b32 s46, s46, 17
    s_add_u32 s46, s46, s47
    ds_read_b64_tr_b16 a[132:133], v26 offset:4096
    s_waitcnt lgkmcnt(7)
    ds_read_b64_tr_b16 a[134:135], v26 offset:6144
    s_waitcnt vmcnt(7)
    buffer_load_dwordx4 v8, s[28:31], s46 offen offset:0 lds
    ds_read_b64_tr_b16 a[136:137], v27 offset:4096
    ds_read_b64_tr_b16 a[138:139], v27 offset:6144
    s_waitcnt vmcnt(7)
    buffer_load_dwordx4 v9, s[28:31], s46 offen offset:1024 lds
    ds_read_b64_tr_b16 a[140:141], v28 offset:4096
    ds_read_b64_tr_b16 a[142:143], v28 offset:6144
    s_waitcnt vmcnt(7)
    buffer_load_dwordx4 v10, s[28:31], s46 offen offset:2048 lds
    ds_read_b64_tr_b16 a[144:145], v25 offset:8192
    s_waitcnt lgkmcnt(7)
    ds_read_b64_tr_b16 a[146:147], v25 offset:10240
    s_waitcnt vmcnt(7)
    buffer_load_dwordx4 v11, s[28:31], s46 offen offset:3072 lds
    ds_read_b64_tr_b16 a[148:149], v26 offset:8192
    ds_read_b64_tr_b16 a[150:151], v26 offset:10240
    s_waitcnt vmcnt(6)
    v_cmp_ne_u32 vcc, s57, v60
    s_cbranch_vccz L_pa_ok
    s_mov_b32 s53, 0
L_pa_l:
    global_load_dword v60, v36, s[18:19] sc1
    s_add_u32 s53, s53, 1
    s_cmp_ge_u32 s53, 400000
    s_cbranch_scc1 L_pa_ok
    s_waitcnt vmcnt(0)
    v_cmp_ne_u32 vcc, s57, v60
    s_cbranch_vccnz L_pa_l
L_pa_ok:
    buffer_load_dwordx4 v[144:147], v16, s[32:35], s60 offen sc1
    ds_read_b64_tr_b16 a[152:153], v27 offset:8192
    ds_read_b64_tr_b16 a[154:155], v27 offset:10240
    buffer_load_dwordx4 v[148:151], v16, s[32:35], s61 offen sc1
    ds_read_b64_tr_b16 a[156:157], v28 offset:8192
    s_waitcnt lgkmcnt(7)
    ds_read_b64_tr_b16 a[158:159], v28 offset:10240
    s_waitcnt vmcnt(7)
    buffer_load_dwordx4 v[152:155], v16, s[32:35], s62 offen sc1
    s_waitcnt vmcnt(7)
    buffer_load_dwordx4 v[156:159], v16, s[32:35], s63 offen sc1
    ds_read_b64_tr_b16 a[160:161], v25 offset:12288
    ds_read_b64_tr_b16 a[162:163], v25 offset:14336
    s_waitcnt vmcnt(7)
    buffer_load_dwordx4 v[160:163], v16, s[32:35], s64 offen sc1
    ds_read_b64_tr_b16 a[164:165], v26 offset:12288
    ds_read_b64_tr_b16 a[166:167], v26 offset:14336
    s_waitcnt vmcnt(7)
    buffer_load_dwordx4 v[164:167], v16, s[32:35], s65 offen sc1
    ds_read_b64_tr_b16 a[168:169], v27 offset:12288
    s_waitcnt lgkmcnt(7)
    ds_read_b64_tr_b16 a[170:171], v27 offset:14336
    s_waitcnt vmcnt(7)
    buffer_load_dwordx4 v[168:171], v16, s[32:35], s66 offen sc1
    ds_read_b64_tr_b16 a[172:173], v28 offset:12288
    ds_read_b64_tr_b16 a[174:175], v28 offset:14336
    s_waitcnt vmcnt(7)
    buffer_load_dwordx4 v[172:175], v16, s[32:35], s67 offen sc1
    ds_read_b64_tr_b16 a[176:177], v25 offset:16384
    ds_read_b64_tr_b16 a[178:179], v25 offset:18432
    ds_read_b64_tr_b16 a[180:181], v26 offset:16384
    s_waitcnt lgkmcnt(7)
    ds_read_b64_tr_b16 a[182:183], v26 offset:18432
    ds_read_b64_tr_b16 a[184:185], v27 offset:16384
    ds_read_b64_tr_b16 a[186:187], v27 offset:18432
    ds_read_b64_tr_b16 a[188:189], v28 offset:16384
    ds_read_b64_tr_b16 a[190:191], v28 offset:18432
    s_waitcnt lgkmcnt(0)
    s_waitcnt vmcnt(6)
    v_mfma_f32_16x16x32_bf16 v[68:71], v[144:147], a[4:7], 0
    v_mfma_f32_16x16x32_bf16 v[68:71], v[148:151], a[20:23], v[68:71]
    buffer_load_dwordx4 v[176:179], v16, s[32:35], s68 offen sc1
    v_mfma_f32_16x16x32_bf16 v[72:75], v[144:147], a[8:11], 0
    v_mfma_f32_16x16x32_bf16 v[72:75], v[148:151], a[24:27], v[72:75]
    buffer_load_dwordx4 v[180:183], v16, s[32:35], s69 offen sc1
    v_mfma_f32_16x16x32_bf16 v[76:79], v[144:147], a[12:15], 0
    v_mfma_f32_16x16x32_bf16 v[76:79], v[148:151], a[28:31], v[76:79]
    buffer_load_dwordx4 v[184:187], v16, s[32:35], s70 offen sc1
    v_mfma_f32_16x16x32_bf16 v[64:67], v[144:147], a[0:3], v[64:67]
    v_mfma_f32_16x16x32_bf16 v[64:67], v[148:151], a[16:19], v[64:67]
    s_waitcnt vmcnt(7)
    v_mfma_f32_16x16x32_bf16 v[68:71], v[152:155], a[36:39], v[68:71]
    v_mfma_f32_16x16x32_bf16 v[68:71], v[156:159], a[52:55], v[68:71]
    buffer_load_dwordx4 v[188:191], v16, s[32:35], s71 offen sc1
    v_mfma_f32_16x16x32_bf16 v[72:75], v[152:155], a[40:43], v[72:75]
    v_mfma_f32_16x16x32_bf16 v[72:75], v[156:159], a[56:59], v[72:75]
    buffer_load_dwordx4 v[192:195], v17, s[32:35], s60 offen sc1
    v_mfma_f32_16x16x32_bf16 v[76:79], v[152:155], a[44:47], v[76:79]
    v_mfma_f32_16x16x32_bf16 v[76:79], v[156:159], a[60:63], v[76:79]
    buffer_load_dwordx4 v[196:199], v17, s[32:35], s61 offen sc1
    v_mfma_f32_16x16x32_bf16 v[64:67], v[152:155], a[32:35], v[64:67]
    v_mfma_f32_16x16x32_bf16 v[64:67], v[156:159], a[48:51], v[64:67]
    s_waitcnt vmcnt(8)
    v_mfma_f32_16x16x32_bf16 v[68:71], v[160:163], a[68:71], v[68:71]
    v_mfma_f32_16x16x32_bf16 v[68:71], v[164:167], a[84:87], v[68:71]
    global_load_dword v60, v37, s[18:19] sc1
    buffer_load_dwordx4 v[200:203], v17, s[32:35], s62 offen sc1
    v_mfma_f32_16x16x32_bf16 v[72:75], v[160:163], a[72:75], v[72:75]
    v_mfma_f32_16x16x32_bf16 v[72:75], v[164:167], a[88:91], v[72:75]
    v_mfma_f32_16x16x32_bf16 v[76:79], v[160:163], a[76:79], v[76:79]
    v_mfma_f32_16x16x32_bf16 v[76:79], v[164:167], a[92:95], v[76:79]
    buffer_load_dwordx4 v[204:207], v17, s[32:35], s63 offen sc1
    v_mfma_f32_16x16x32_bf16 v[64:67], v[160:163], a[64:67], v[64:67]
    v_mfma_f32_16x16x32_bf16 v[64:67], v[164:167], a[80:83], v[64:67]
    s_waitcnt vmcnt(9)
    v_mfma_f32_16x16x32_bf16 v[68:71], v[168:171], a[100:103], v[68:71]
    v_mfma_f32_16x16x32_bf16 v[68:71], v[172:175], a[116:119], v[68:71]
    buffer_load_dwordx4 v[144:147], v17, s[32:35], s64 offen sc1
    v_mfma_f32_16x16x32_bf16 v[72:75], v[168:171], a[104:107], v[72:75]
    v_mfma_f32_16x16x32_bf16 v[72:75], v[172:175], a[120:123], v[72:75]
    v_mfma_f32_16x16x32_bf16 v[76:79], v[168:171], a[108:111], v[76:79]
    v_mfma_f32_16x16x32_bf16 v[76:79], v[172:175], a[124:127], v[76:79]
    buffer_load_dwordx4 v[148:151], v17, s[32:35], s65 offen sc1
    v_mfma_f32_16x16x32_bf16 v[64:67], v[168:171], a[96:99], v[64:67]
    v_mfma_f32_16x16x32_bf16 v[64:67], v[172:175], a[112:115], v[64:67]
    s_waitcnt vmcnt(9)
    v_mfma_f32_16x16x32_bf16 v[68:71], v[176:179], a[132:135], v[68:71]
    v_mfma_f32_16x16x32_bf16 v[68:71], v[180:183], a[148:151], v[68:71]
    buffer_load_dwordx4 v[152:155], v17, s[32:35], s66 offen sc1
    v_mfma_f32_16x16x32_bf16 v[72:75], v[176:179], a[136:139], v[72:75]
    v_mfma_f32_16x16x32_bf16 v[72:75], v[180:183], a[152:155], v[72:75]
    v_mfma_f32_16x16x32_bf16 v[76:79], v[176:179], a[140:143], v[76:79]
    v_mfma_f32_16x16x32_bf16 v[76:79], v[180:183], a[156:159], v[76:79]
    buffer_load_dwordx4 v[156:159], v17, s[32:35], s67 offen sc1
    v_mfma_f32_16x16x32_bf16 v[64:67], v[176:179], a[128:131], v[64:67]
    v_mfma_f32_16x16x32_bf16 v[64:67], v[180:183], a[144:147], v[64:67]
    s_waitcnt vmcnt(9)
    v_mfma_f32_16x16x32_bf16 v[68:71], v[184:187], a[164:167], v[68:71]
    v_mfma_f32_16x16x32_bf16 v[68:71], v[188:191], a[180:183], v[68:71]
    buffer_load_dwordx4 v[160:163], v17, s[32:35], s68 offen sc1
    v_mfma_f32_16x16x32_bf16 v[72:75], v[184:187], a[168:171], v[72:75]
    v_mfma_f32_16x16x32_bf16 v[72:75], v[188:191], a[184:187], v[72:75]
    v_mfma_f32_16x16x32_bf16 v[76:79], v[184:187], a[172:175], v[76:79]
    v_mfma_f32_16x16x32_bf16 v[76:79], v[188:191], a[188:191], v[76:79]
    buffer_load_dwordx4 v[164:167], v17, s[32:35], s69 offen sc1
    v_mfma_f32_16x16x32_bf16 v[64:67], v[184:187], a[160:163], v[64:67]
    v_mfma_f32_16x16x32_bf16 v[64:67], v[188:191], a[176:179], v[64:67]
    s_waitcnt vmcnt(9)
    v_mfma_f32_16x16x32_bf16 v[84:87], v[192:195], a[4:7], 0
    v_mfma_f32_16x16x32_bf16 v[84:87], v[196:199], a[20:23], v[84:87]
    buffer_load_dwordx4 v[168:171], v17, s[32:35], s70 offen sc1
    v_mfma_f32_16x16x32_bf16 v[88:91], v[192:195], a[8:11], 0
    v_mfma_f32_16x16x32_bf16 v[88:91], v[196:199], a[24:27], v[88:91]
    v_mfma_f32_16x16x32_bf16 v[92:95], v[192:195], a[12:15], 0
    v_mfma_f32_16x16x32_bf16 v[92:95], v[196:199], a[28:31], v[92:95]
    s_waitcnt vmcnt(9)
    v_cmp_ne_u32 vcc, s57, v60
    buffer_load_dwordx4 v[172:175], v17, s[32:35], s71 offen sc1
    v_mfma_f32_16x16x32_bf16 v[80:83], v[192:195], a[0:3], v[80:83]
    v_mfma_f32_16x16x32_bf16 v[80:83], v[196:199], a[16:19], v[80:83]
    s_waitcnt vmcnt(8)
    v_mfma_f32_16x16x32_bf16 v[84:87], v[200:203], a[36:39], v[84:87]
    ds_write_b128 v29, v[68:71] offset:0
    v_mfma_f32_16x16x32_bf16 v[84:87], v[204:207], a[52:55], v[84:87]
    s_cbranch_vccnz L_pb_spin
L_pb_ok:
    buffer_load_dwordx4 v[176:179], v18, s[32:35], s60 offen sc1
    v_mfma_f32_16x16x32_bf16 v[88:91], v[200:203], a[40:43], v[88:91]
    v_mfma_f32_16x16x32_bf16 v[88:91], v[204:207], a[56:59], v[88:91]
    ds_write_b128 v29, v[72:75] offset:5120
    v_mfma_f32_16x16x32_bf16 v[92:95], v[200:203], a[44:47], v[92:95]
    v_mfma_f32_16x16x32_bf16 v[92:95], v[204:207], a[60:63], v[92:95]
    buffer_load_dwordx4 v[180:183], v18, s[32:35], s61 offen sc1
    v_mfma_f32_16x16x32_bf16 v[80:83], v[200:203], a[32:35], v[80:83]
    ds_write_b128 v29, v[76:79] offset:10240
    v_mfma_f32_16x16x32_bf16 v[80:83], v[204:207], a[48:51], v[80:83]
    s_waitcnt vmcnt(8)
    v_mfma_f32_16x16x32_bf16 v[84:87], v[144:147], a[68:71], v[84:87]
    v_mfma_f32_16x16x32_bf16 v[84:87], v[148:151], a[84:87], v[84:87]
    buffer_load_dwordx4 v[184:187], v18, s[32:35], s62 offen sc1
    v_mfma_f32_16x16x32_bf16 v[88:91], v[144:147], a[72:75], v[88:91]
    v_mfma_f32_16x16x32_bf16 v[88:91], v[148:151], a[88:91], v[88:91]
    v_mfma_f32_16x16x32_bf16 v[92:95], v[144:147], a[76:79], v[92:95]
    v_mfma_f32_16x16x32_bf16 v[92:95], v[148:151], a[92:95], v[92:95]
    buffer_load_dwordx4 v[188:191], v18, s[32:35], s63 offen sc1
    v_mfma_f32_16x16x32_bf16 v[80:83], v[144:147], a[64:67], v[80:83]
    v_mfma_f32_16x16x32_bf16 v[80:83], v[148:151], a[80:83], v[80:83]
    s_waitcnt vmcnt(8)
    v_mfma_f32_16x16x32_bf16 v[84:87], v[152:155], a[100:103], v[84:87]
    v_mfma_f32_16x16x32_bf16 v[84:87], v[156:159], a[116:119], v[84:87]
    buffer_load_dwordx4 v[192:195], v18, s[32:35], s64 offen sc1
    v_mfma_f32_16x16x32_bf16 v[88:91], v[152:155], a[104:107], v[88:91]
    v_mfma_f32_16x16x32_bf16 v[88:91], v[156:159], a[120:123], v[88:91]
    v_mfma_f32_16x16x32_bf16 v[92:95], v[152:155], a[108:111], v[92:95]
    v_mfma_f32_16x16x32_bf16 v[92:95], v[156:159], a[124:127], v[92:95]
    buffer_load_dwordx4 v[196:199], v18, s[32:35], s65 offen sc1
    v_mfma_f32_16x16x32_bf16 v[80:83], v[152:155], a[96:99], v[80:83]
    v_mfma_f32_16x16x32_bf16 v[80:83], v[156:159], a[112:115], v[80:83]
    s_waitcnt vmcnt(8)
    v_mfma_f32_16x16x32_bf16 v[84:87], v[160:163], a[132:135], v[84:87]
    v_mfma_f32_16x16x32_bf16 v[84:87], v[164:167], a[148:151], v[84:87]
    buffer_load_dwordx4 v[200:203], v18, s[32:35], s66 offen sc1
    v_mfma_f32_16x16x32_bf16 v[88:91], v[160:163], a[136:139], v[88:91]
    v_mfma_f32_16x16x32_bf16 v[88:91], v[164:167], a[152:155], v[88:91]
    v_mfma_f32_16x16x32_bf16 v[92:95], v[160:163], a[140:143], v[92:95]
    v_mfma_f32_16x16x32_bf16 v[92:95], v[164:167], a[156:159], v[92:95]
    buffer_load_dwordx4 v[204:207], v18, s[32:35], s67 offen sc1
    v_mfma_f32_16x16x32_bf16 v[80:83], v[160:163], a[128:131], v[80:83]
    v_mfma_f32_16x16x32_bf16 v[80:83], v[164:167], a[144:147], v[80:83]
    s_waitcnt vmcnt(8)
    v_mfma_f32_16x16x32_bf16 v[84:87], v[168:171], a[164:167], v[84:87]
    v_mfma_f32_16x16x32_bf16 v[84:87], v[172:175], a[180:183], v[84:87]
    buffer_load_dwordx4 v[144:147], v18, s[32:35], s68 offen sc1
    v_mfma_f32_16x16x32_bf16 v[88:91], v[168:171], a[168:171], v[88:91]
    v_mfma_f32_16x16x32_bf16 v[88:91], v[172:175], a[184:187], v[88:91]
    v_mfma_f32_16x16x32_bf16 v[92:95], v[168:171], a[172:175], v[92:95]
    v_mfma_f32_16x16x32_bf16 v[92:95], v[172:175], a[188:191], v[92:95]
    buffer_load_dwordx4 v[148:151], v18, s[32:35], s69 offen sc1
    v_mfma_f32_16x16x32_bf16 v[80:83], v[168:171], a[160:163], v[80:83]
    v_mfma_f32_16x16x32_bf16 v[80:83], v[172:175], a[176:179], v[80:83]
    s_waitcnt vmcnt(8)
    v_mfma_f32_16x16x32_bf16 v[100:103], v[176:179], a[4:7], 0
    v_mfma_f32_16x16x32_bf16 v[100:103], v[180:183], a[20:23], v[100:103]
    buffer_load_dwordx4 v[152:155], v18, s[32:35], s70 offen sc1
    v_mfma_f32_16x16x32_bf16 v[104:107], v[176:179], a[8:11], 0
    v_mfma_f32_16x16x32_bf16 v[104:107], v[180:183], a[24:27], v[104:107]
    v_mfma_f32_16x16x32_bf16 v[108:111], v[176:179], a[12:15], 0
    v_mfma_f32_16x16x32_bf16 v[108:111], v[180:183], a[28:31], v[108:111]
    buffer_load_dwordx4 v[156:159], v18, s[32:35], s71 offen sc1
    v_mfma_f32_16x16x32_bf16 v[96:99], v[176:179], a[0:3], v[96:99]
    v_mfma_f32_16x16x32_bf16 v[96:99], v[180:183], a[16:19], v[96:99]
    s_waitcnt vmcnt(8)
    v_mfma_f32_16x16x32_bf16 v[100:103], v[184:187], a[36:39], v[100:103]
    ds_write_b128 v29, v[84:87] offset:1024
    v_mfma_f32_16x16x32_bf16 v[100:103], v[188:191], a[52:55], v[100:103]
    buffer_load_dwordx4 v[160:163], v19, s[32:35], s60 offen sc1
    v_mfma_f32_16x16x32_bf16 v[104:107], v[184:187], a[40:43], v[104:107]
    v_mfma_f32_16x16x32_bf16 v[104:107], v[188:191], a[56:59], v[104:107]
    ds_write_b128 v29, v[88:91] offset:6144
    v_mfma_f32_16x16x32_bf16 v[108:111], v[184:187], a[44:47], v[108:111]
    v_mfma_f32_16x16x32_bf16 v[108:111], v[188:191], a[60:63], v[108:111]
    buffer_load_dwordx4 v[164:167], v19, s[32:35], s61 offen sc1
    v_mfma_f32_16x16x32_bf16 v[96:99], v[184:187], a[32:35], v[96:99]
    ds_write_b128 v29, v[92:95] offset:11264
    v_mfma_f32_16x16x32_bf16 v[96:99], v[188:191], a[48:51], v[96:99]
    s_waitcnt vmcnt(8)
    v_mfma_f32_16x16x32_bf16 v[100:103], v[192:195], a[68:71], v[100:103]
    v_mfma_f32_16x16x32_bf16 v[100:103], v[196:199], a[84:87], v[100:103]
    buffer_load_dwordx4 v[168:171], v19, s[32:35], s62 offen sc1
    v_mfma_f32_16x16x32_bf16 v[104:107], v[192:195], a[72:75], v[104:107]
    v_mfma_f32_16x16x32_bf16 v[104:107], v[196:199], a[88:91], v[104:107]
    v_mfma_f32_16x16x32_bf16 v[108:111], v[192:195], a[76:79], v[108:111]
    v_mfma_f32_16x16x32_bf16 v[108:111], v[196:199], a[92:95], v[108:111]
    buffer_load_dwordx4 v[172:175], v19, s[32:35], s63 offen sc1
    v_mfma_f32_16x16x32_bf16 v[96:99], v[192:195], a[64:67], v[96:99]
    v_mfma_f32_16x16x32_bf16 v[96:99], v[196:199], a[80:83], v[96:99]
    s_waitcnt lgkmcnt(0)
    s_barrier
    s_waitcnt vmcnt(8)
    v_mfma_f32_16x16x32_bf16 v[100:103], v[200:203], a[100:103], v[100:103]
    ds_read_b128 v[68:71], v30 offset:0
    v_mfma_f32_16x16x32_bf16 v[100:103], v[204:207], a[116:119], v[100:103]
    buffer_load_dwordx4 v[176:179], v19, s[32:35], s64 offen sc1
    v_mfma_f32_16x16x32_bf16 v[104:107], v[200:203], a[104:107], v[104:107]
    ds_read_b128 v[72:75], v31 offset:5120
    v_mfma_f32_16x16x32_bf16 v[104:107], v[204:207], a[120:123], v[104:107]
    ds_read_b128 v[76:79], v32 offset:10240
    v_mfma_f32_16x16x32_bf16 v[108:111], v[200:203], a[108:111], v[108:111]
    ds_read_b128 v[84:87], v30 offset:1024
    v_mfma_f32_16x16x32_bf16 v[108:111], v[204:207], a[124:127], v[108:111]
    buffer_load_dwordx4 v[180:183], v19, s[32:35], s65 offen sc1
    v_mfma_f32_16x16x32_bf16 v[96:99], v[200:203], a[96:99], v[96:99]
    ds_read_b128 v[88:91], v31 offset:6144
    v_mfma_f32_16x16x32_bf16 v[96:99], v[204:207], a[112:115], v[96:99]
    ds_read_b128 v[92:95], v32 offset:11264
    s_waitcnt vmcnt(8)
    v_mfma_f32_16x16x32_bf16 v[100:103], v[144:147], a[132:135], v[100:103]
    v_mfma_f32_16x16x32_bf16 v[100:103], v[148:151], a[148:151], v[100:103]
    buffer_load_dwordx4 v[184:187], v19, s[32:35], s66 offen sc1
    v_mfma_f32_16x16x32_bf16 v[104:107], v[144:147], a[136:139], v[104:107]
    v_mfma_f32_16x16x32_bf16 v[104:107], v[148:151], a[152:155], v[104:107]
    v_mfma_f32_16x16x32_bf16 v[108:111], v[144:147], a[140:143], v[108:111]
    v_mfma_f32_16x16x32_bf16 v[108:111], v[148:151], a[156:159], v[108:111]
    buffer_load_dwordx4 v[188:191], v19, s[32:35], s67 offen sc1
    v_mfma_f32_16x16x32_bf16 v[96:99], v[144:147], a[128:131], v[96:99]
    s_waitcnt lgkmcnt(3)
    v_mfma_f32_16x16x32_bf16 v[96:99], v[148:151], a[144:147], v[96:99]
    v_add_f32 v64, v64, v68
    s_waitcnt vmcnt(8)
    v_mfma_f32_16x16x32_bf16 v[100:103], v[152:155], a[164:167], v[100:103]
    v_add_f32 v72, v72, v76
    v_mfma_f32_16x16x32_bf16 v[100:103], v[156:159], a[180:183], v[100:103]
    buffer_load_dwordx4 v[192:195], v19, s[32:35], s68 offen sc1
    v_mfma_f32_16x16x32_bf16 v[104:107], v[152:155], a[168:171], v[104:107]
    v_add_f32 v65, v65, v69
    v_mfma_f32_16x16x32_bf16 v[104:107], v[156:159], a[184:187], v[104:107]
    v_add_f32 v73, v73, v77
    v_mfma_f32_16x16x32_bf16 v[108:111], v[152:155], a[172:175], v[108:111]
    v_add_f32 v66, v66, v70
    v_mfma_f32_16x16x32_bf16 v[108:111], v[156:159], a[188:191], v[108:111]
    buffer_load_dwordx4 v[196:199], v19, s[32:35], s69 offen sc1
    v_mfma_f32_16x16x32_bf16 v[96:99], v[152:155], a[160:163], v[96:99]
    v_add_f32 v74, v74, v78
    v_mfma_f32_16x16x32_bf16 v[96:99], v[156:159], a[176:179], v[96:99]
    v_add_f32 v67, v67, v71
    s_waitcnt vmcnt(8)
    v_mfma_f32_16x16x32_bf16 v[116:119], v[160:163], a[4:7], 0
    v_add_f32 v75, v75, v79
    v_mfma_f32_16x16x32_bf16 v[116:119], v[164:167], a[20:23], v[116:119]
    buffer_load_dwordx4 v[200:203], v19, s[32:35], s70 offen sc1
    v_mfma_f32_16x16x32_bf16 v[120:123], v[160:163], a[8:11], 0
    v_add_f32 v64, v64, v72
    v_mfma_f32_16x16x32_bf16 v[120:123], v[164:167], a[24:27], v[120:123]
    v_add_f32 v65, v65, v73
    v_mfma_f32_16x16x32_bf16 v[124:127], v[160:163], a[12:15], 0
    v_add_f32 v66, v66, v74
    v_mfma_f32_16x16x32_bf16 v[124:127], v[164:167], a[28:31], v[124:127]
    buffer_load_dwordx4 v[204:207], v19, s[32:35], s71 offen sc1
    v_mfma_f32_16x16x32_bf16 v[112:115], v[160:163], a[0:3], v[112:115]
    v_add_f32 v67, v67, v75
    v_mfma_f32_16x16x32_bf16 v[112:115], v[164:167], a[16:19], v[112:115]
    v_cvt_pk_bf16_f32 v208, v64, v65
    s_waitcnt vmcnt(8)
    v_mfma_f32_16x16x32_bf16 v[116:119], v[168:171], a[36:39], v[116:119]
    ds_write_b128 v29, v[100:103] offset:2048
    v_mfma_f32_16x16x32_bf16 v[116:119], v[172:175], a[52:55], v[116:119]
    buffer_load_dwordx4 v[144:147], v20, s[32:35], s60 offen sc1
    v_mfma_f32_16x16x32_bf16 v[120:123], v[168:171], a[40:43], v[120:123]
    v_mfma_f32_16x16x32_bf16 v[120:123], v[172:175], a[56:59], v[120:123]
    ds_write_b128 v29, v[104:107] offset:7168
    v_mfma_f32_16x16x32_bf16 v[124:127], v[168:171], a[44:47], v[124:127]
    v_mfma_f32_16x16x32_bf16 v[124:127], v[172:175], a[60:63], v[124:127]
    buffer_load_dwordx4 v[148:151], v20, s[32:35], s61 offen sc1
    v_mfma_f32_16x16x32_bf16 v[112:115], v[168:171], a[32:35], v[112:115]
    ds_write_b128 v29, v[108:111] offset:12288
    v_mfma_f32_16x16x32_bf16 v[112:115], v[172:175], a[48:51], v[112:115]
    s_waitcnt vmcnt(8)
    v_mfma_f32_16x16x32_bf16 v[116:119], v[176:179], a[68:71], v[116:119]
    v_cvt_pk_bf16_f32 v209, v66, v67
    v_mfma_f32_16x16x32_bf16 v[116:119], v[180:183], a[84:87], v[116:119]
    buffer_load_dwordx4 v[152:155], v20, s[32:35], s62 offen sc1
    v_mfma_f32_16x16x32_bf16 v[120:123], v[176:179], a[72:75], v[120:123]
    s_waitcnt lgkmcnt(3)
    v_mfma_f32_16x16x32_bf16 v[120:123], v[180:183], a[88:91], v[120:123]
    v_add_f32 v80, v80, v84
    v_mfma_f32_16x16x32_bf16 v[124:127], v[176:179], a[76:79], v[124:127]
    v_add_f32 v88, v88, v92
    v_mfma_f32_16x16x32_bf16 v[124:127], v[180:183], a[92:95], v[124:127]
    buffer_load_dwordx4 v[156:159], v20, s[32:35], s63 offen sc1
    v_mfma_f32_16x16x32_bf16 v[112:115], v[176:179], a[64:67], v[112:115]
    v_add_f32 v81, v81, v85
    v_mfma_f32_16x16x32_bf16 v[112:115], v[180:183], a[80:83], v[112:115]
    v_add_f32 v89, v89, v93
    s_waitcnt vmcnt(8)
    v_mfma_f32_16x16x32_bf16 v[116:119], v[184:187], a[100:103], v[116:119]
    v_add_f32 v82, v82, v86
    v_mfma_f32_16x16x32_bf16 v[116:119], v[188:191], a[116:119], v[116:119]
    buffer_load_dwordx4 v[160:163], v20, s[32:35], s64 offen sc1
    v_mfma_f32_16x16x32_bf16 v[120:123], v[184:187], a[104:107], v[120:123]
    v_add_f32 v90, v90, v94
    v_mfma_f32_16x16x32_bf16 v[120:123], v[188:191], a[120:123], v[120:123]
    v_add_f32 v83, v83, v87
    v_mfma_f32_16x16x32_bf16 v[124:127], v[184:187], a[108:111], v[124:127]
    v_add_f32 v91, v91, v95
    v_mfma_f32_16x16x32_bf16 v[124:127], v[188:191], a[124:127], v[124:127]
    buffer_load_dwordx4 v[164:167], v20, s[32:35], s65 offen sc1
    v_mfma_f32_16x16x32_bf16 v[112:115], v[184:187], a[96:99], v[112:115]
    v_add_f32 v80, v80, v88
    v_mfma_f32_16x16x32_bf16 v[112:115], v[188:191], a[112:115], v[112:115]
    v_add_f32 v81, v81, v89
    s_waitcnt vmcnt(8)
    v_mfma_f32_16x16x32_bf16 v[116:119], v[192:195], a[132:135], v[116:119]
    v_add_f32 v82, v82, v90
    v_mfma_f32_16x16x32_bf16 v[116:119], v[196:199], a[148:151], v[116:119]
    buffer_load_dwordx4 v[168:171], v20, s[32:35], s66 offen sc1
    v_mfma_f32_16x16x32_bf16 v[120:123], v[192:195], a[136:139], v[120:123]
    v_add_f32 v83, v83, v91
    v_mfma_f32_16x16x32_bf16 v[120:123], v[196:199], a[152:155], v[120:123]
    v_cvt_pk_bf16_f32 v210, v80, v81
    v_mfma_f32_16x16x32_bf16 v[124:127], v[192:195], a[140:143], v[124:127]
    v_cvt_pk_bf16_f32 v211, v82, v83
    v_mfma_f32_16x16x32_bf16 v[124:127], v[196:199], a[156:159], v[124:127]
    buffer_load_dwordx4 v[172:175], v20, s[32:35], s67 offen sc1
    v_mfma_f32_16x16x32_bf16 v[112:115], v[192:195], a[128:131], v[112:115]
    v_mfma_f32_16x16x32_bf16 v[112:115], v[196:199], a[144:147], v[112:115]
    s_waitcnt vmcnt(8)
    v_mfma_f32_16x16x32_bf16 v[116:119], v[200:203], a[164:167], v[116:119]
    v_mfma_f32_16x16x32_bf16 v[116:119], v[204:207], a[180:183], v[116:119]
    buffer_load_dwordx4 v[176:179], v20, s[32:35], s68 offen sc1
    v_mfma_f32_16x16x32_bf16 v[120:123], v[200:203], a[168:171], v[120:123]
    v_mfma_f32_16x16x32_bf16 v[120:123], v[204:207], a[184:187], v[120:123]
    v_mfma_f32_16x16x32_bf16 v[124:127], v[200:203], a[172:175], v[124:127]
    v_mfma_f32_16x16x32_bf16 v[124:127], v[204:207], a[188:191], v[124:127]
    buffer_load_dwordx4 v[180:183], v20, s[32:35], s69 offen sc1
    v_mfma_f32_16x16x32_bf16 v[112:115], v[200:203], a[160:163], v[112:115]
    v_mfma_f32_16x16x32_bf16 v[112:115], v[204:207], a[176:179], v[112:115]
    s_waitcnt vmcnt(8)
    v_mfma_f32_16x16x32_bf16 v[132:135], v[144:147], a[4:7], 0
    v_mfma_f32_16x16x32_bf16 v[132:135], v[148:151], a[20:23], v[132:135]
    buffer_load_dwordx4 v[184:187], v20, s[32:35], s70 offen sc1
    v_mfma_f32_16x16x32_bf16 v[136:139], v[144:147], a[8:11], 0
    v_mfma_f32_16x16x32_bf16 v[136:139], v[148:151], a[24:27], v[136:139]
    v_mfma_f32_16x16x32_bf16 v[140:143], v[144:147], a[12:15], 0
    v_mfma_f32_16x16x32_bf16 v[140:143], v[148:151], a[28:31], v[140:143]
    buffer_load_dwordx4 v[188:191], v20, s[32:35], s71 offen sc1
    v_mfma_f32_16x16x32_bf16 v[128:131], v[144:147], a[0:3], v[128:131]
    v_mfma_f32_16x16x32_bf16 v[128:131], v[148:151], a[16:19], v[128:131]
    s_waitcnt vmcnt(8)
    v_mfma_f32_16x16x32_bf16 v[132:135], v[152:155], a[36:39], v[132:135]
    ds_write_b128 v29, v[116:119] offset:3072
    v_mfma_f32_16x16x32_bf16 v[132:135], v[156:159], a[52:55], v[132:135]
    v_mfma_f32_16x16x32_bf16 v[136:139], v[152:155], a[40:43], v[136:139]
    ds_write_b128 v29, v[120:123] offset:8192
    v_mfma_f32_16x16x32_bf16 v[136:139], v[156:159], a[56:59], v[136:139]
    v_mfma_f32_16x16x32_bf16 v[140:143], v[152:155], a[44:47], v[140:143]
    ds_write_b128 v29, v[124:127] offset:13312
    v_mfma_f32_16x16x32_bf16 v[140:143], v[156:159], a[60:63], v[140:143]
    v_mfma_f32_16x16x32_bf16 v[128:131], v[152:155], a[32:35], v[128:131]
    v_mfma_f32_16x16x32_bf16 v[128:131], v[156:159], a[48:51], v[128:131]
    s_waitcnt lgkmcnt(0)
    s_barrier
    s_waitcnt vmcnt(6)
    v_mfma_f32_16x16x32_bf16 v[132:135], v[160:163], a[68:71], v[132:135]
    ds_read_b128 v[100:103], v30 offset:2048
    ds_read_b128 v[104:107], v31 offset:7168
    v_mfma_f32_16x16x32_bf16 v[132:135], v[164:167], a[84:87], v[132:135]
    ds_read_b128 v[108:111], v32 offset:12288
    ds_read_b128 v[116:119], v30 offset:3072
    v_mfma_f32_16x16x32_bf16 v[136:139], v[160:163], a[72:75], v[136:139]
    ds_read_b128 v[120:123], v31 offset:8192
    ds_read_b128 v[124:127], v32 offset:13312
    v_mfma_f32_16x16x32_bf16 v[136:139], v[164:167], a[88:91], v[136:139]
    buffer_store_dwordx4 v[208:211], v33, s[36:39], s49 offen offset:0 sc1
    v_mfma_f32_16x16x32_bf16 v[140:143], v[160:163], a[76:79], v[140:143]
    v_mfma_f32_16x16x32_bf16 v[140:143], v[164:167], a[92:95], v[140:143]
    s_waitcnt lgkmcnt(3)
    v_add_f32 v96, v96, v100
    s_waitcnt vmcnt(5)
    v_mfma_f32_16x16x32_bf16 v[132:135], v[168:171], a[100:103], v[132:135]
    v_add_f32 v104, v104, v108
    v_add_f32 v97, v97, v101
    v_mfma_f32_16x16x32_bf16 v[132:135], v[172:175], a[116:119], v[132:135]
    v_add_f32 v105, v105, v109
    v_add_f32 v98, v98, v102
    v_mfma_f32_16x16x32_bf16 v[136:139], v[168:171], a[104:107], v[136:139]
    v_add_f32 v106, v106, v110
    v_add_f32 v99, v99, v103
    v_mfma_f32_16x16x32_bf16 v[136:139], v[172:175], a[120:123], v[136:139]
    v_add_f32 v107, v107, v111
    v_add_f32 v96, v96, v104
    v_mfma_f32_16x16x32_bf16 v[140:143], v[168:171], a[108:111], v[140:143]
    v_add_f32 v97, v97, v105
    v_add_f32 v98, v98, v106
    v_mfma_f32_16x16x32_bf16 v[140:143], v[172:175], a[124:127], v[140:143]
    v_add_f32 v99, v99, v107
    v_cvt_pk_bf16_f32 v212, v96, v97
    s_waitcnt vmcnt(3)
    v_mfma_f32_16x16x32_bf16 v[132:135], v[176:179], a[132:135], v[132:135]
    v_cvt_pk_bf16_f32 v213, v98, v99
    s_waitcnt lgkmcnt(0)
    v_mfma_f32_16x16x32_bf16 v[132:135], v[180:183], a[148:151], v[132:135]
    v_add_f32 v112, v112, v116
    v_add_f32 v120, v120, v124
    v_mfma_f32_16x16x32_bf16 v[136:139], v[176:179], a[136:139], v[136:139]
    v_add_f32 v113, v113, v117
    v_add_f32 v121, v121, v125
    v_mfma_f32_16x16x32_bf16 v[136:139], v[180:183], a[152:155], v[136:139]
    v_add_f32 v114, v114, v118
    v_add_f32 v122, v122, v126
    v_mfma_f32_16x16x32_bf16 v[140:143], v[176:179], a[140:143], v[140:143]
    v_add_f32 v115, v115, v119
    v_add_f32 v123, v123, v127
    v_mfma_f32_16x16x32_bf16 v[140:143], v[180:183], a[156:159], v[140:143]
    v_add_f32 v112, v112, v120
    v_add_f32 v113, v113, v121
    s_waitcnt vmcnt(1)
    v_mfma_f32_16x16x32_bf16 v[132:135], v[184:187], a[164:167], v[132:135]
    v_add_f32 v114, v114, v122
    v_add_f32 v115, v115, v123
    v_mfma_f32_16x16x32_bf16 v[132:135], v[188:191], a[180:183], v[132:135]
    v_cvt_pk_bf16_f32 v214, v112, v113
    v_cvt_pk_bf16_f32 v215, v114, v115
    v_mfma_f32_16x16x32_bf16 v[136:139], v[184:187], a[168:171], v[136:139]
    buffer_store_dwordx4 v[212:215], v33, s[36:39], s49 offen offset:64 sc1
    v_mfma_f32_16x16x32_bf16 v[136:139], v[188:191], a[184:187], v[136:139]
    v_mfma_f32_16x16x32_bf16 v[140:143], v[184:187], a[172:175], v[140:143]
    v_mfma_f32_16x16x32_bf16 v[140:143], v[188:191], a[188:191], v[140:143]
    v_mfma_f32_16x16x32_bf16 v[128:131], v[160:163], a[64:67], v[128:131]
    v_mfma_f32_16x16x32_bf16 v[128:131], v[164:167], a[80:83], v[128:131]
    v_mfma_f32_16x16x32_bf16 v[128:131], v[168:171], a[96:99], v[128:131]
    v_mfma_f32_16x16x32_bf16 v[128:131], v[172:175], a[112:115], v[128:131]
    ds_write_b128 v29, v[132:135] offset:4096
    v_mfma_f32_16x16x32_bf16 v[128:131], v[176:179], a[128:131], v[128:131]
    ds_write_b128 v29, v[136:139] offset:9216
    v_mfma_f32_16x16x32_bf16 v[128:131], v[180:183], a[144:147], v[128:131]
    ds_write_b128 v29, v[140:143] offset:14336
    v_mfma_f32_16x16x32_bf16 v[128:131], v[184:187], a[160:163], v[128:131]
    v_mfma_f32_16x16x32_bf16 v[128:131], v[188:191], a[176:179], v[128:131]
    s_waitcnt lgkmcnt(0)
    s_barrier
    ds_read_b128 v[132:135], v30 offset:4096
    ds_read_b128 v[136:139], v31 offset:9216
    ds_read_b128 v[140:143], v32 offset:14336
    s_nop 1
    s_waitcnt lgkmcnt(0)
    v_pk_add_f32 v[128:129], v[128:129], v[132:133]
    v_pk_add_f32 v[136:137], v[136:137], v[140:141]
    v_pk_add_f32 v[130:131], v[130:131], v[134:135]
    v_pk_add_f32 v[138:139], v[138:139], v[142:143]
    v_pk_add_f32 v[128:129], v[128:129], v[136:137]
    v_pk_add_f32 v[130:131], v[130:131], v[138:139]
    v_cvt_pk_bf16_f32 v216, v128, v129
    v_cvt_pk_bf16_f32 v217, v130, v131
    buffer_store_dwordx2 v[216:217], v34, s[36:39], s56 offen
    s_endpgm
L_pb_spin:
    s_mov_b32 s53, 0
L_pb_l:
    global_load_dword v60, v37, s[18:19] sc1
    s_add_u32 s53, s53, 1
    s_cmp_ge_u32 s53, 400000
    s_cbranch_scc1 L_pb_ok
    s_waitcnt vmcnt(0)
    v_cmp_ne_u32 vcc, s57, v60
    s_cbranch_vccnz L_pb_l
    s_branch L_pb_ok
L_idle:
    s_mov_b32 s28, s10
    s_mov_b32 s29, s11
    s_mov_b32 s30, 6291456
    s_mov_b32 s31, 0x00020000
    s_bfe_u32 s51, s2, 0x10003
    s_mul_i32 s55, s51, 4
    s_add_u32 s55, s55, 2
    s_lshl_b32 s51, s51, 16
    s_mul_i32 s50, s40, 1572864
    s_add_u32 s50, s50, s51
    s_lshr_b32 s51, s45, 2
    s_lshl_b32 s51, s51, 9
    s_add_u32 s56, s50, s51
    v_lshrrev_b32 v12, 2, v1
    v_lshlrev_b32 v12, 12, v12
    v_and_b32 v55, 3, v1
    v_lshl_add_u32 v12, v55, 7, v12
    buffer_load_dword v13, v12, s[28:31], s56 offen
    s_add_u32 s56, s56, 131072
    s_mul_i32 s20, s57, 1664524
    s_add_u32 s20, s20, 1013904223
    s_add_u32 s57, s57, s20
    v_mov_b32 v39, s57
    s_sub_u32 s0, s57, s0
    s_sub_u32 s1, s57, s1
    s_sub_u32 s59, s57, s59
    v_lshrrev_b32 v54, 2, v1
    v_lshlrev_b32 v21, 7, v54
    v_bfe_u32 v54, v1, 3, 2
    v_lshl_add_u32 v21, v54, 5, v21
    v_and_b32 v54, 3, v1
    v_lshl_add_u32 v21, v54, 3, v21
    v_add_u32 v21, s41, v21
    s_lshl_b32 s50, s40, 5
    v_xor_b32 v25, s50, v21
    s_and_b32 s50, s40, 1
    s_lshl_b32 s50, s50, 6
    v_xor_b32 v21, s50, v21
    v_xor_b32 v22, 32, v21
    v_xor_b32 v23, 64, v21
    v_xor_b32 v24, 96, v21
    v_lshrrev_b32 v57, 4, v1
    v_mul_u32_u24 v33, 1280, v33
    v_lshl_add_u32 v34, v57, 3, v33
    v_lshl_add_u32 v33, v57, 4, v33
    v_xor_b32 v26, 32, v25
    v_xor_b32 v27, 64, v25
    v_xor_b32 v28, 96, v25
    v_add_u32 v9, 31744, v8
    v_add_u32 v10, 63488, v8
    v_add_u32 v11, 95232, v8
    v_and_b32 v16, 0x70, v52
    v_lshrrev_b32 v54, 3, v1
    v_lshl_add_u32 v53, v54, 8, v16
    v_lshl_add_u32 v16, v54, 8, v16
    v_add_u32 v17, 98304, v16
    v_add_u32 v18, 196608, v16
    v_add_u32 v19, 294912, v16
    v_add_u32 v20, 393216, v16
    v_min_u32 v54, 23, v1
    v_mul_u32_u24 v55, 43, v54
    v_lshrrev_b32 v55, 9, v55
    v_mul_u32_u24 v55, 18, v55
    v_lshrrev_b32 v56, 1, v54
    s_mul_i32 s50, s44, 120
    s_mul_i32 s51, s40, 6
    s_add_u32 s50, s50, s51
    v_add3_u32 v55, v55, v56, s50
    v_and_b32 v54, 1, v54
    v_lshlrev_b32 v54, 2, v54
    v_lshl_add_u32 v36, v55, 6, v54
    v_add_u32 v36, 32768, v36
    v_min_u32 v54, 35, v1
    v_mul_u32_u24 v55, 43, v54
    v_lshrrev_b32 v55, 9, v55
    v_mul_u32_u24 v55, 18, v55
    v_lshrrev_b32 v56, 1, v54
    s_mul_i32 s50, s44, 120
    s_mul_i32 s51, s40, 6
    s_add_u32 s50, s50, s51
    v_add3_u32 v55, v55, v56, s50
    v_and_b32 v54, 1, v54
    v_lshlrev_b32 v54, 2, v54
    v_lshl_add_u32 v37, v55, 6, v54
    v_add_u32 v37, 35840, v37
    s_mov_b32 s28, s10
    s_mov_b32 s29, s11
    s_mov_b32 s30, 6291456
    s_mov_b32 s31, 0x00020000
    s_mov_b32 s36, s14
    s_mov_b32 s37, s15
    s_mov_b32 s38, 2621440
    s_mov_b32 s39, 0x00020000
    s_waitcnt vmcnt(1)
    s_atomic_add s0, s[4:5], s16
    s_waitcnt vmcnt(0)
    buffer_load_dword v13, v12, s[28:31], s56 offen
    s_add_u32 s56, s56, 131072
    s_waitcnt vmcnt(0)
    buffer_load_dword v13, v12, s[28:31], s56 offen
    s_add_u32 s56, s56, 131072
    s_waitcnt vmcnt(0)
    buffer_load_dword v13, v12, s[28:31], s56 offen
    s_add_u32 s56, s56, 131072
    s_waitcnt vmcnt(0)
    s_mul_i32 s47, s40, 1572864
    s_lshl_b32 s50, s45, 7
    s_add_u32 s47, s47, s50
    s_add_u32 s48, s47, 1572864
    s_mov_b32 m0, s41
    s_add_u32 s46, s47, 0
    buffer_load_dwordx4 v8, s[28:31], s46 offen offset:0 lds
    buffer_load_dwordx4 v9, s[28:31], s46 offen offset:1024 lds
    buffer_load_dwordx4 v10, s[28:31], s46 offen offset:2048 lds
    buffer_load_dwordx4 v11, s[28:31], s46 offen offset:3072 lds
    s_add_u32 m0, m0, 4096
    s_add_u32 s46, s47, 131072
    buffer_load_dwordx4 v8, s[28:31], s46 offen offset:0 lds
    buffer_load_dwordx4 v9, s[28:31], s46 offen offset:1024 lds
    buffer_load_dwordx4 v10, s[28:31], s46 offen offset:2048 lds
    buffer_load_dwordx4 v11, s[28:31], s46 offen offset:3072 lds
    s_add_u32 m0, m0, 4096
    s_add_u32 s46, s47, 262144
    buffer_load_dwordx4 v8, s[28:31], s46 offen offset:0 lds
    buffer_load_dwordx4 v9, s[28:31], s46 offen offset:1024 lds
    buffer_load_dwordx4 v10, s[28:31], s46 offen offset:2048 lds
    buffer_load_dwordx4 v11, s[28:31], s46 offen offset:3072 lds
    s_add_u32 m0, m0, 4096
    s_add_u32 s46, s55, 0
    s_and_b32 s46, s46, 7
    s_add_u32 s46, s46, 4
    s_lshl_b32 s46, s46, 17
    s_add_u32 s46, s46, s47
    buffer_load_dwordx4 v8, s[28:31], s46 offen offset:0 lds
    buffer_load_dwordx4 v9, s[28:31], s46 offen offset:1024 lds
    buffer_load_dwordx4 v10, s[28:31], s46 offen offset:2048 lds
    buffer_load_dwordx4 v11, s[28:31], s46 offen offset:3072 lds
    s_add_u32 m0, m0, 4096
    s_add_u32 s46, s47, 393216
    buffer_load_dwordx4 v8, s[28:31], s46 offen offset:0 lds
    buffer_load_dwordx4 v9, s[28:31], s46 offen offset:1024 lds
    buffer_load_dwordx4 v10, s[28:31], s46 offen offset:2048 lds
    buffer_load_dwordx4 v11, s[28:31], s46 offen offset:3072 lds
    s_add_u32 m0, m0, 4096
    s_add_u32 s46, s55, 1
    s_and_b32 s46, s46, 7
    s_add_u32 s46, s46, 4
    s_lshl_b32 s46, s46, 17
    s_add_u32 s46, s46, s47
    buffer_load_dwordx4 v8, s[28:31], s46 offen offset:0 lds
    buffer_load_dwordx4 v9, s[28:31], s46 offen offset:1024 lds
    buffer_load_dwordx4 v10, s[28:31], s46 offen offset:2048 lds
    buffer_load_dwordx4 v11, s[28:31], s46 offen offset:3072 lds
    s_add_u32 m0, m0, 4096
    s_add_u32 s46, s55, 2
    s_and_b32 s46, s46, 7
    s_add_u32 s46, s46, 4
    s_lshl_b32 s46, s46, 17
    s_add_u32 s46, s46, s47
    buffer_load_dwordx4 v8, s[28:31], s46 offen offset:0 lds
    s_waitcnt vmcnt(0)
    ds_read_b64_tr_b16 a[0:1], v25 offset:0
    ds_read_b64_tr_b16 a[2:3], v25 offset:2048
    ds_read_b64_tr_b16 a[4:5], v26 offset:0
    ds_read_b64_tr_b16 a[6:7], v26 offset:2048
    ds_read_b64_tr_b16 a[8:9], v27 offset:0
    ds_read_b64_tr_b16 a[10:11], v27 offset:2048
    ds_read_b64_tr_b16 a[12:13], v28 offset:0
    ds_read_b64_tr_b16 a[14:15], v28 offset:2048
    ds_read_b64_tr_b16 a[16:17], v25 offset:4096
    ds_read_b64_tr_b16 a[18:19], v25 offset:6144
    ds_read_b64_tr_b16 a[20:21], v26 offset:4096
    ds_read_b64_tr_b16 a[22:23], v26 offset:6144
    ds_read_b64_tr_b16 a[24:25], v27 offset:4096
    s_waitcnt lgkmcnt(7)
    ds_read_b64_tr_b16 a[26:27], v27 offset:6144
    ds_read_b64_tr_b16 a[28:29], v28 offset:4096
    ds_read_b64_tr_b16 a[30:31], v28 offset:6144
    ds_read_b64_tr_b16 a[32:33], v25 offset:8192
    ds_read_b64_tr_b16 a[34:35], v25 offset:10240
    ds_read_b64_tr_b16 a[36:37], v26 offset:8192
    s_waitcnt lgkmcnt(7)
    ds_read_b64_tr_b16 a[38:39], v26 offset:10240
    ds_read_b64_tr_b16 a[40:41], v27 offset:8192
    ds_read_b64_tr_b16 a[42:43], v27 offset:10240
    ds_read_b64_tr_b16 a[44:45], v28 offset:8192
    ds_read_b64_tr_b16 a[46:47], v28 offset:10240
    ds_read_b64_tr_b16 a[48:49], v25 offset:12288
    s_waitcnt lgkmcnt(7)
    ds_read_b64_tr_b16 a[50:51], v25 offset:14336
    ds_read_b64_tr_b16 a[52:53], v26 offset:12288
    ds_read_b64_tr_b16 a[54:55], v26 offset:14336
    s_waitcnt lgkmcnt(0)
    s_branch L_join
L_end:
    s_endpgm
.section .rodata,"a"
.p2align 6
.amdhsa_kernel standalone__mixer_token_mlp__prompt_kernel
  .amdhsa_next_free_vgpr 512
  .amdhsa_next_free_sgpr 102
  .amdhsa_accum_offset 256
  .amdhsa_group_segment_fixed_size 0
  .amdhsa_kernarg_size 64
  .amdhsa_user_sgpr_count 2
  .amdhsa_user_sgpr_kernarg_segment_ptr 1
  .amdhsa_system_sgpr_workgroup_id_x 1
  .amdhsa_float_denorm_mode_32 3
.end_amdhsa_kernel
```
